```python
import torch

def _softmax(x, axis=-1):
    return torch.softmax(x, dim=axis)
def _gelu(x):
    return torch.nn.functional.gelu(x, approximate="tanh")
def _silu(x):
    return torch.nn.functional.silu(x)
def _sigmoid(x):
    return torch.sigmoid(x)
def _layernorm(x, axis=-1, eps=1e-5):
    m = x.mean(dim=axis, keepdim=True)
    v = x.var(dim=axis, keepdim=True, unbiased=False)
    return (x - m) / torch.sqrt(v + eps)
def _scatter_add(tgt, idx, src, axis=0):
    return tgt.clone().index_add_(axis, idx, src)
def _segment_sum(src, seg, n):
    out = torch.zeros((n,) + src.shape[1:], dtype=src.dtype)
    return out.index_add_(0, seg, src)
def _pad(x, pw):
    flat = tuple(v for pair in reversed(pw) for v in pair)
    return torch.nn.functional.pad(x, flat)

kernel_name = 'gated_mix__sliding_block__sliding_local_dilated__prompt'

def setup_inputs():

    _w = (lambda a: (lambda t: t.to(torch.bfloat16) if t.is_floating_point() else t)(torch.as_tensor(a)))
    def _A_setup():
        B, S, D = 1, 2048, 512
        return {
            "x": _w((lambda *s: torch.randn(*s, dtype=torch.bfloat16) * 0.05)(B, S, D)),
            "wqkv": _w((lambda *s: torch.randn(*s, dtype=torch.bfloat16) * 1.6)(D, 3 * D)),
            "wo": _w((lambda *s: torch.randn(*s, dtype=torch.bfloat16) * 0.05)(D, D)),
        }
    _A_in = _A_setup()

    def _B_setup():
        B, S, D = 1, 2048, 512
        return {
            "x": _w((lambda *s: torch.randn(*s, dtype=torch.bfloat16) * 0.05)(B, S, D)),
            "wqkv": _w((lambda *s: torch.randn(*s, dtype=torch.bfloat16) * 1.6)(D, 3 * D)),
            "wo": _w((lambda *s: torch.randn(*s, dtype=torch.bfloat16) * 0.05)(D, D)),
        }
    _B_in = _B_setup()

    return {
        "A_x": _A_in["x"],
        "A_wqkv": _A_in["wqkv"],
        "A_wo": _A_in["wo"],
        "B_x": _B_in["x"],
        "B_wqkv": _B_in["wqkv"],
        "B_wo": _B_in["wo"],
        "gate_w": _w((lambda *s: torch.randn(*s, dtype=torch.bfloat16) * 0.05)(512) * 16.0),
    }

def reference(A_x, A_wqkv, A_wo, B_x, B_wqkv, B_wo, gate_w):
    def _A_ref(x, wqkv, wo):
        B, S, D = x.shape
        H = 32; Dh = D // H; W = 256
        qkv = (lambda x, *d: x.permute(*d))((x @ wqkv).reshape(B, S, 3, H, Dh), 2, 0, 3, 1, 4)
        q, k, v = qkv[0], qkv[1], qkv[2]
        scores = torch.einsum("bhqd,bhkd->bhqk", q, k) * (Dh ** -0.5)
        idx = torch.arange(S)
        mask = (idx[:, None] - idx[None, :] >= 0) & (idx[:, None] - idx[None, :] < W)
        scores = torch.where(mask[None, None], scores, -1e9)
        p = _softmax(scores, axis=-1)
        o = torch.einsum("bhqk,bhkd->bhqd", p, v)
        return (lambda x, *d: x.permute(*d))(o, 0, 2, 1, 3).reshape(B, S, D) @ wo

    def _B_ref(x, wqkv, wo):
        B, S, D = x.shape
        H = 32; Dh = D // H
        W, dil = 8, 2
        qkv = (lambda x, *d: x.permute(*d))((x @ wqkv).reshape(B, S, 3, H, Dh), 2, 0, 3, 1, 4)
        q, k, v = qkv[0], qkv[1], qkv[2]
        scale = Dh ** -0.5
        pos = torch.arange(S)
        off = torch.arange(W) * dil
        idx = pos[:, None] - off[None, :]
        mask = idx >= 0
        idx_c = torch.where(mask, idx, 0).reshape(-1)
        kg = k[:, :, idx_c, :].reshape(B, H, S, W, Dh)
        vg = v[:, :, idx_c, :].reshape(B, H, S, W, Dh)
        logits = torch.einsum("bhsd,bhswd->bhsw", q, kg) * scale
        logits = torch.where(mask[None, None, :, :], logits, -1e9)
        attn = _softmax(logits, axis=-1)
        o = torch.einsum("bhsw,bhswd->bhsd", attn, vg)
        return (lambda x, *d: x.permute(*d))(o, 0, 2, 1, 3).reshape(B, S, D) @ wo

    x = A_x
    g = _sigmoid((x * gate_w).sum(-1, keepdims=True))
    a = _A_ref(x, A_wqkv, A_wo)
    b = _B_ref(x, B_wqkv, B_wo)
    return g * a + (1 - g) * b
```

```asm
; @launch grid=(256,1,1) block=(512,1,1) lds=158720
.amdgcn_target "amdgcn-amd-amdhsa--gfx950"
.text
.globl gated_mix__sliding_block__sliding_local_dilated__prompt_kernel
.p2align 12
.p2align 8
.type gated_mix__sliding_block__sliding_local_dilated__prompt_kernel,@function
gated_mix__sliding_block__sliding_local_dilated__prompt_kernel:
    s_cmp_ge_u32 s2, 256
    s_cbranch_scc1 L_end
    s_load_dwordx16 s[4:19], s[0:1], 0
    s_load_dwordx4 s[20:23], s[0:1], 64
    v_lshrrev_b32 v4, 6, v0
    v_and_b32 v1, 63, v0
    s_lshr_b32 s60, s2, 3
    v_readfirstlane_b32 s62, v4
    s_and_b32 s63, s2, 3
    s_and_b32 s59, s60, 1
    s_lshl1_add_u32 s53, s63, s59
    s_bfe_u32 s59, s2, 0x10002
    s_lshl_b32 s54, s59, 4
    s_lshr_b32 s55, s60, 1
    s_add_u32 s54, s54, s55
    s_and_b32 s52, s62, 3
    s_cmp_lt_u32 s62, 4
    s_cbranch_scc1 L_crole
    s_add_u32 s55, s55, s53
    s_and_b32 s55, s55, 7
    v_lshrrev_b32 v32, 3, v1
    v_lshrrev_b32 v33, 4, v1
    v_and_b32 v34, 7, v1
    s_lshl_b32 s60, s52, 4
    v_add_u32 v35, s60, v32
    v_lshlrev_b32 v35, 10, v35
    v_xor_b32 v36, v34, v33
    v_lshl_add_u32 v160, v36, 4, v35
    v_xor_b32 v161, 64, v160
    v_add_u32 v161, 7168, v161
    s_lshr_b32 s60, s52, 1
    s_and_b32 s63, s52, 1
    s_lshl_b32 s59, s60, 4
    v_add_u32 v35, s59, v33
    v_mul_u32_u24 v35, 0xc00, v35
    v_lshlrev_b32 v36, 1, v33
    v_xor_b32 v36, v36, v34
    v_lshl_add_u32 v35, v36, 4, v35
    v_and_b32 v36, 1, v32
    v_xor_b32 v36, s63, v36
    v_lshlrev_b32 v36, 10, v36
    s_lshl_b32 s96, s53, 7
    s_add_u32 s59, s96, 1024
    v_add3_u32 v162, v35, v36, s59
    v_add_u32 v163, 11264, v162
    v_xor_b32 v36, 0x400, v36
    v_add3_u32 v164, v35, v36, s59
    v_add_u32 v165, 33792, v164
    v_add_u32 v164, 22528, v164
    s_lshl_b32 s61, s63, 13
    s_lshl_b32 s59, s60, 12
    s_add_u32 s61, s61, s59
    s_lshl_b32 s62, s52, 11
    s_add_u32 s62, s62, 81920
    s_waitcnt lgkmcnt(0)
    s_mov_b32 s24, s4
    s_mov_b32 s25, s5
    s_mov_b32 s26, 2097152
    s_mov_b32 s27, 0x20000
    s_cmp_eq_u32 s63, 0
    s_cselect_b32 s28, s6, s12
    s_cselect_b32 s29, s7, s13
    s_mov_b32 s30, 1572864
    s_mov_b32 s31, 0x20000
    s_add_u32 s59, s55, 0
    s_and_b32 s59, s59, 7
    s_lshl_b32 s59, s59, 7
    s_lshl_b32 s96, s54, 16
    s_add_u32 m0, s62, 0
    s_add_u32 s59, s59, s96
    buffer_load_dwordx4 v160, s[24:27], s59 offen lds
    buffer_load_dwordx4 v161, s[24:27], s59 offen offset:1024 lds
    s_lshl_b32 s97, s55, 1
    s_add_u32 s97, s97, 0
    s_and_b32 s97, s97, 15
    s_add_u32 m0, s61, 0
    s_mul_i32 s97, s97, 98304
    buffer_load_dwordx4 v162, s[28:31], s97 offen lds
    buffer_load_dwordx4 v163, s[28:31], s97 offen offset:1024 lds
    buffer_load_dwordx4 v164, s[28:31], s97 offen offset:2048 lds
    buffer_load_dwordx4 v165, s[28:31], s97 offen offset:3072 lds
    s_lshl_b32 s97, s55, 1
    s_add_u32 s97, s97, 1
    s_and_b32 s97, s97, 15
    s_add_u32 m0, s61, 16384
    s_mul_i32 s97, s97, 98304
    buffer_load_dwordx4 v162, s[28:31], s97 offen lds
    buffer_load_dwordx4 v163, s[28:31], s97 offen offset:1024 lds
    buffer_load_dwordx4 v164, s[28:31], s97 offen offset:2048 lds
    buffer_load_dwordx4 v165, s[28:31], s97 offen offset:3072 lds
    s_getpc_b64 s[78:79]
L_pc:
    s_sub_u32 s78, s78, L_pc-gated_mix__sliding_block__sliding_local_dilated__prompt_kernel
    s_subb_u32 s79, s79, 0
    s_lshr_b32 s63, s2, 3
    s_lshl2_add_u32 s63, s63, s52
    s_lshl_b32 s63, s63, 8
    s_load_dword s80, s[78:79], s63 offset:0
    s_load_dword s81, s[78:79], s63 offset:64
    s_load_dword s82, s[78:79], s63 offset:128
    s_load_dword s83, s[78:79], s63 offset:192
    s_lshl_b32 s59, s55, 3
    v_add_u32 v37, s59, v1
    v_and_b32 v37, 63, v37
    v_lshlrev_b32 v37, 4, v37
    s_mov_b32 s36, s16
    s_mov_b32 s37, s17
    s_mov_b32 s38, 1024
    s_mov_b32 s39, 0x20000
    s_mov_b32 m0, 156672
    s_nop 0
    buffer_load_dwordx4 v37, s[36:39], 0 offen lds
    s_lshr_b32 s60, s2, 3
    s_and_b32 s57, s2, 7
    s_lshl_b32 s57, s57, 2
    s_lshr_b32 s63, s60, 3
    s_add_u32 s57, s57, s63
    s_and_b32 s58, s60, 7
    s_lshl_b32 s56, s53, 2
    s_add_u32 s56, s56, s52
    s_mov_b32 s98, 0xffff
    s_mov_b32 s99, 0xffff
    v_lshlrev_b32 v2, 4, v1
    s_lshr_b32 s60, s52, 1
    s_and_b32 s63, s52, 1
    s_lshl_b32 s60, s60, 5
    v_add_u32 v35, s60, v32
    v_mul_u32_u24 v35, 0xc00, v35
    v_and_b32 v36, 1, v33
    v_lshlrev_b32 v36, 1, v36
    v_xor_b32 v36, v36, v34
    v_lshlrev_b32 v36, 4, v36
    s_lshl_b32 s60, s53, 7
    v_add3_u32 v166, v35, v36, s60
    v_xor_b32 v36, 64, v36
    v_add3_u32 v167, v35, v36, s60
    v_add_u32 v168, 47104, v166
    v_add_u32 v169, 70656, v167
    v_add_u32 v167, 23552, v167
    s_mov_b32 s32, s22
    s_mov_b32 s33, s23
    s_mov_b32 s34, 16777216
    s_mov_b32 s35, 0x20000
    s_mov_b32 s48, s20
    s_mov_b32 s49, s21
    s_mov_b32 s50, 256
    s_mov_b32 s51, 0x20000
    s_waitcnt vmcnt(5)
    s_barrier
    s_add_u32 s59, s55, 1
    s_and_b32 s59, s59, 7
    s_lshl_b32 s59, s59, 7
    s_lshl_b32 s96, s54, 16
    s_add_u32 m0, s62, 8192
    s_add_u32 s59, s59, s96
    buffer_load_dwordx4 v160, s[24:27], s59 offen lds
    buffer_load_dwordx4 v161, s[24:27], s59 offen offset:1024 lds
    s_lshl_b32 s97, s55, 1
    s_add_u32 s97, s97, 2
    s_and_b32 s97, s97, 15
    s_add_u32 m0, s61, 32768
    s_mul_i32 s97, s97, 98304
    buffer_load_dwordx4 v162, s[28:31], s97 offen lds
    buffer_load_dwordx4 v163, s[28:31], s97 offen offset:1024 lds
    buffer_load_dwordx4 v164, s[28:31], s97 offen offset:2048 lds
    buffer_load_dwordx4 v165, s[28:31], s97 offen offset:3072 lds
    s_lshl_b32 s97, s55, 1
    s_add_u32 s97, s97, 3
    s_and_b32 s97, s97, 15
    s_add_u32 m0, s61, 49152
    s_mul_i32 s97, s97, 98304
    buffer_load_dwordx4 v162, s[28:31], s97 offen lds
    buffer_load_dwordx4 v163, s[28:31], s97 offen offset:1024 lds
    buffer_load_dwordx4 v164, s[28:31], s97 offen offset:2048 lds
    buffer_load_dwordx4 v165, s[28:31], s97 offen offset:3072 lds
    s_waitcnt vmcnt(10)
    s_barrier
    s_add_u32 s59, s55, 2
    s_and_b32 s59, s59, 7
    s_lshl_b32 s59, s59, 7
    s_lshl_b32 s96, s54, 16
    s_add_u32 m0, s62, 16384
    s_add_u32 s59, s59, s96
    buffer_load_dwordx4 v160, s[24:27], s59 offen lds
    buffer_load_dwordx4 v161, s[24:27], s59 offen offset:1024 lds
    s_lshl_b32 s97, s55, 1
    s_add_u32 s97, s97, 4
    s_and_b32 s97, s97, 15
    s_add_u32 m0, s61, 65536
    s_mul_i32 s97, s97, 98304
    buffer_load_dwordx4 v162, s[28:31], s97 offen lds
    buffer_load_dwordx4 v163, s[28:31], s97 offen offset:1024 lds
    buffer_load_dwordx4 v164, s[28:31], s97 offen offset:2048 lds
    buffer_load_dwordx4 v165, s[28:31], s97 offen offset:3072 lds
    s_lshl_b32 s97, s55, 1
    s_add_u32 s97, s97, 5
    s_and_b32 s97, s97, 15
    s_add_u32 m0, s61, 0
    s_mul_i32 s97, s97, 98304
    buffer_load_dwordx4 v162, s[28:31], s97 offen lds
    buffer_load_dwordx4 v163, s[28:31], s97 offen offset:1024 lds
    buffer_load_dwordx4 v164, s[28:31], s97 offen offset:2048 lds
    buffer_load_dwordx4 v165, s[28:31], s97 offen offset:3072 lds
    s_waitcnt vmcnt(14)
    s_barrier
    s_add_u32 s59, s55, 3
    s_and_b32 s59, s59, 7
    s_lshl_b32 s59, s59, 7
    s_lshl_b32 s96, s54, 16
    s_add_u32 m0, s62, 24576
    s_add_u32 s59, s59, s96
    buffer_load_dwordx4 v160, s[24:27], s59 offen lds
    buffer_load_dwordx4 v161, s[24:27], s59 offen offset:1024 lds
    s_lshl_b32 s97, s55, 1
    s_add_u32 s97, s97, 6
    s_and_b32 s97, s97, 15
    s_add_u32 m0, s61, 16384
    s_mul_i32 s97, s97, 98304
    buffer_load_dwordx4 v162, s[28:31], s97 offen lds
    buffer_load_dwordx4 v163, s[28:31], s97 offen offset:1024 lds
    buffer_load_dwordx4 v164, s[28:31], s97 offen offset:2048 lds
    buffer_load_dwordx4 v165, s[28:31], s97 offen offset:3072 lds
    s_waitcnt vmcnt(16)
    s_barrier
    s_lshl_b32 s97, s55, 1
    s_add_u32 s97, s97, 7
    s_and_b32 s97, s97, 15
    s_add_u32 m0, s61, 32768
    s_mul_i32 s97, s97, 98304
    buffer_load_dwordx4 v162, s[28:31], s97 offen lds
    buffer_load_dwordx4 v163, s[28:31], s97 offen offset:1024 lds
    buffer_load_dwordx4 v164, s[28:31], s97 offen offset:2048 lds
    buffer_load_dwordx4 v165, s[28:31], s97 offen offset:3072 lds
    s_mov_b32 s63, 0
    s_load_dword s70, s[22:23], s63
    s_mov_b32 s63, 2097152
    s_load_dword s71, s[22:23], s63
    s_waitcnt vmcnt(14)
    s_barrier
    s_add_u32 s59, s55, 4
    s_and_b32 s59, s59, 7
    s_lshl_b32 s59, s59, 7
    s_lshl_b32 s96, s54, 16
    s_add_u32 m0, s62, 32768
    s_add_u32 s59, s59, s96
    buffer_load_dwordx4 v160, s[24:27], s59 offen lds
    buffer_load_dwordx4 v161, s[24:27], s59 offen offset:1024 lds
    s_lshl_b32 s97, s55, 1
    s_add_u32 s97, s97, 8
    s_and_b32 s97, s97, 15
    s_add_u32 m0, s61, 49152
    s_mul_i32 s97, s97, 98304
    buffer_load_dwordx4 v162, s[28:31], s97 offen lds
    buffer_load_dwordx4 v163, s[28:31], s97 offen offset:1024 lds
    buffer_load_dwordx4 v164, s[28:31], s97 offen offset:2048 lds
    buffer_load_dwordx4 v165, s[28:31], s97 offen offset:3072 lds
    s_mov_b32 s63, 4194304
    s_load_dword s70, s[22:23], s63
    s_mov_b32 s63, 8388608
    s_load_dword s71, s[22:23], s63
    s_waitcnt vmcnt(16)
    s_barrier
    s_lshl_b32 s97, s55, 1
    s_add_u32 s97, s97, 9
    s_and_b32 s97, s97, 15
    s_add_u32 m0, s61, 65536
    s_mul_i32 s97, s97, 98304
    buffer_load_dwordx4 v162, s[28:31], s97 offen lds
    buffer_load_dwordx4 v163, s[28:31], s97 offen offset:1024 lds
    buffer_load_dwordx4 v164, s[28:31], s97 offen offset:2048 lds
    buffer_load_dwordx4 v165, s[28:31], s97 offen offset:3072 lds
    s_mov_b32 s63, 6291456
    s_load_dword s70, s[22:23], s63
    s_mov_b32 s63, 0
    s_load_dword s71, s[20:21], s63
    s_waitcnt vmcnt(14)
    s_barrier
    s_add_u32 s59, s55, 5
    s_and_b32 s59, s59, 7
    s_lshl_b32 s59, s59, 7
    s_lshl_b32 s96, s54, 16
    s_add_u32 m0, s62, 40960
    s_add_u32 s59, s59, s96
    buffer_load_dwordx4 v160, s[24:27], s59 offen lds
    buffer_load_dwordx4 v161, s[24:27], s59 offen offset:1024 lds
    s_lshl_b32 s97, s55, 1
    s_add_u32 s97, s97, 10
    s_and_b32 s97, s97, 15
    s_add_u32 m0, s61, 0
    s_mul_i32 s97, s97, 98304
    buffer_load_dwordx4 v162, s[28:31], s97 offen lds
    buffer_load_dwordx4 v163, s[28:31], s97 offen offset:1024 lds
    buffer_load_dwordx4 v164, s[28:31], s97 offen offset:2048 lds
    buffer_load_dwordx4 v165, s[28:31], s97 offen offset:3072 lds
    s_mov_b32 s63, 0
    s_load_dword s70, s[18:19], s63
    s_waitcnt vmcnt(16)
    s_barrier
    s_lshl_b32 s97, s55, 1
    s_add_u32 s97, s97, 11
    s_and_b32 s97, s97, 15
    s_add_u32 m0, s61, 16384
    s_mul_i32 s97, s97, 98304
    buffer_load_dwordx4 v162, s[28:31], s97 offen lds
    buffer_load_dwordx4 v163, s[28:31], s97 offen offset:1024 lds
    buffer_load_dwordx4 v164, s[28:31], s97 offen offset:2048 lds
    buffer_load_dwordx4 v165, s[28:31], s97 offen offset:3072 lds
    s_waitcnt vmcnt(14)
    s_barrier
    s_add_u32 s59, s55, 6
    s_and_b32 s59, s59, 7
    s_lshl_b32 s59, s59, 7
    s_lshl_b32 s96, s54, 16
    s_add_u32 m0, s62, 49152
    s_add_u32 s59, s59, s96
    buffer_load_dwordx4 v160, s[24:27], s59 offen lds
    buffer_load_dwordx4 v161, s[24:27], s59 offen offset:1024 lds
    s_lshl_b32 s97, s55, 1
    s_add_u32 s97, s97, 12
    s_and_b32 s97, s97, 15
    s_add_u32 m0, s61, 32768
    s_mul_i32 s97, s97, 98304
    buffer_load_dwordx4 v162, s[28:31], s97 offen lds
    buffer_load_dwordx4 v163, s[28:31], s97 offen offset:1024 lds
    buffer_load_dwordx4 v164, s[28:31], s97 offen offset:2048 lds
    buffer_load_dwordx4 v165, s[28:31], s97 offen offset:3072 lds
    s_lshl2_add_u32 s63, s2, s52
    s_lshl_b32 s63, s63, 9
    s_load_dword s73, s[14:15], s63 offset:0
    s_load_dword s74, s[14:15], s63 offset:64
    s_load_dword s75, s[14:15], s63 offset:128
    s_load_dword s76, s[14:15], s63 offset:192
    buffer_load_dwordx2 v[6:7], off, s[48:51], 0 sc1
    s_waitcnt vmcnt(17)
    s_barrier
    s_lshl_b32 s97, s55, 1
    s_add_u32 s97, s97, 13
    s_and_b32 s97, s97, 15
    s_add_u32 m0, s61, 49152
    s_mul_i32 s97, s97, 98304
    buffer_load_dwordx4 v162, s[28:31], s97 offen lds
    buffer_load_dwordx4 v163, s[28:31], s97 offen offset:1024 lds
    buffer_load_dwordx4 v164, s[28:31], s97 offen offset:2048 lds
    buffer_load_dwordx4 v165, s[28:31], s97 offen offset:3072 lds
    s_lshl2_add_u32 s63, s2, s52
    s_lshl_b32 s63, s63, 9
    s_load_dword s73, s[14:15], s63 offset:256
    s_load_dword s74, s[14:15], s63 offset:320
    s_load_dword s75, s[14:15], s63 offset:384
    s_load_dword s76, s[14:15], s63 offset:448
    s_waitcnt vmcnt(15)
    s_barrier
    s_add_u32 s59, s55, 7
    s_and_b32 s59, s59, 7
    s_lshl_b32 s59, s59, 7
    s_lshl_b32 s96, s54, 16
    s_add_u32 m0, s62, 57344
    s_add_u32 s59, s59, s96
    buffer_load_dwordx4 v160, s[24:27], s59 offen lds
    buffer_load_dwordx4 v161, s[24:27], s59 offen offset:1024 lds
    s_lshl_b32 s97, s55, 1
    s_add_u32 s97, s97, 14
    s_and_b32 s97, s97, 15
    s_add_u32 m0, s61, 65536
    s_mul_i32 s97, s97, 98304
    buffer_load_dwordx4 v162, s[28:31], s97 offen lds
    buffer_load_dwordx4 v163, s[28:31], s97 offen offset:1024 lds
    buffer_load_dwordx4 v164, s[28:31], s97 offen offset:2048 lds
    buffer_load_dwordx4 v165, s[28:31], s97 offen offset:3072 lds
    s_lshl2_add_u32 s63, s2, s52
    s_lshl_b32 s63, s63, 9
    s_load_dword s73, s[8:9], s63 offset:0
    s_load_dword s74, s[8:9], s63 offset:64
    s_load_dword s75, s[8:9], s63 offset:128
    s_load_dword s76, s[8:9], s63 offset:192
    s_waitcnt vmcnt(17)
    s_barrier
    s_lshl_b32 s97, s55, 1
    s_add_u32 s97, s97, 15
    s_and_b32 s97, s97, 15
    s_add_u32 m0, s61, 0
    s_mul_i32 s97, s97, 98304
    buffer_load_dwordx4 v162, s[28:31], s97 offen lds
    buffer_load_dwordx4 v163, s[28:31], s97 offen offset:1024 lds
    buffer_load_dwordx4 v164, s[28:31], s97 offen offset:2048 lds
    buffer_load_dwordx4 v165, s[28:31], s97 offen offset:3072 lds
    s_lshl2_add_u32 s63, s2, s52
    s_lshl_b32 s63, s63, 9
    s_load_dword s73, s[8:9], s63 offset:256
    s_load_dword s74, s[8:9], s63 offset:320
    s_load_dword s75, s[8:9], s63 offset:384
    s_load_dword s76, s[8:9], s63 offset:448
    s_waitcnt vmcnt(15)
    s_barrier
    s_add_u32 s97, s55, 0
    s_and_b32 s97, s97, 7
    s_add_u32 m0, s61, 16384
    s_mul_i32 s97, s97, 196608
    buffer_load_dwordx4 v166, s[28:31], s97 offen lds
    buffer_load_dwordx4 v167, s[28:31], s97 offen offset:1024 lds
    buffer_load_dwordx4 v168, s[28:31], s97 offen offset:2048 lds
    buffer_load_dwordx4 v169, s[28:31], s97 offen offset:3072 lds
    s_waitcnt vmcnt(14)
    s_barrier
    s_add_u32 s97, s55, 1
    s_and_b32 s97, s97, 7
    s_add_u32 m0, s61, 32768
    s_mul_i32 s97, s97, 196608
    buffer_load_dwordx4 v166, s[28:31], s97 offen lds
    buffer_load_dwordx4 v167, s[28:31], s97 offen offset:1024 lds
    buffer_load_dwordx4 v168, s[28:31], s97 offen offset:2048 lds
    buffer_load_dwordx4 v169, s[28:31], s97 offen offset:3072 lds
    s_waitcnt vmcnt(12)
    s_barrier
    s_add_u32 s97, s55, 2
    s_and_b32 s97, s97, 7
    s_add_u32 m0, s61, 49152
    s_mul_i32 s97, s97, 196608
    buffer_load_dwordx4 v166, s[28:31], s97 offen lds
    buffer_load_dwordx4 v167, s[28:31], s97 offen offset:1024 lds
    buffer_load_dwordx4 v168, s[28:31], s97 offen offset:2048 lds
    buffer_load_dwordx4 v169, s[28:31], s97 offen offset:3072 lds
    v_lshrrev_b32 v48, 5, v1
    v_bfe_u32 v49, v1, 2, 2
    v_lshl_add_u32 v48, v48, 2, v49
    v_and_b32 v49, 2, v49
    v_bfe_u32 v50, v1, 4, 1
    v_xor_b32 v49, v49, v50
    s_and_b32 s63, s52, 2
    v_xor_b32 v49, s63, v49
    v_lshlrev_b32 v49, 5, v49
    v_lshl_add_u32 v48, v48, 7, v49
    v_and_b32 v49, 3, v1
    v_lshl_add_u32 v48, v49, 3, v48
    s_lshl_b32 s62, s52, 14
    s_lshl_b32 s60, s63, 14
    v_add_u32 v16, s60, v48
    v_xor_b32 v17, 64, v16
    v_xor_b32 v49, 64, v48
    s_mul_i32 s60, s63, 6144
    s_add_u32 s60, s60, 132096
    v_add_u32 v24, s60, v48
    v_add_u32 v25, s60, v49
    s_mul_i32 s60, s63, 10240
    s_add_u32 s60, s60, 65536
    v_add_u32 v26, s60, v48
    v_add_u32 v27, s60, v49
    s_waitcnt vmcnt(12)
    s_barrier
    s_add_u32 s97, s55, 3
    s_and_b32 s97, s97, 7
    s_add_u32 m0, s61, 65536
    s_mul_i32 s97, s97, 196608
    buffer_load_dwordx4 v166, s[28:31], s97 offen lds
    buffer_load_dwordx4 v167, s[28:31], s97 offen offset:1024 lds
    buffer_load_dwordx4 v168, s[28:31], s97 offen offset:2048 lds
    buffer_load_dwordx4 v169, s[28:31], s97 offen offset:3072 lds
    s_lshl_b32 s60, s52, 12
    v_add_u32 v23, s60, v2
    v_xor_b32 v20, 0x2000, v23
    v_and_b32 v19, 31, v1
    v_lshlrev_b32 v19, 10, v19
    v_lshrrev_b32 v48, 5, v1
    v_lshl_add_u32 v19, v48, 4, v19
    s_and_b32 s96, s52, 1
    s_lshl_b32 s96, s96, 15
    s_lshl_b32 s60, s57, 16
    s_add_u32 s60, s60, s96
    s_lshl_b32 s63, s58, 7
    s_add_u32 s60, s60, s63
    s_and_b32 s63, s52, 2
    s_lshl_b32 s63, s63, 5
    s_add_u32 s60, s60, s63
    v_add_u32 v19, s60, v19
    s_lshl_b32 s60, s57, 17
    s_add_u32 s60, s60, s96
    s_lshl_b32 s63, s63, 8
    s_add_u32 s60, s60, s63
    s_add_u32 s60, s60, 5242880
    v_add_u32 v18, s60, v2
    s_lshl_b32 s25, s52, 17
    s_lshl_b32 s63, s58, 7
    s_add_u32 s25, s25, s63
    s_lshl3_add_u32 s24, s57, s58
    s_and_b32 s63, s52, 2
    s_lshl2_add_u32 s24, s24, s63
    s_lshl_b32 s24, s24, 6
    s_waitcnt vmcnt(12)
    s_barrier
    s_add_u32 s97, s55, 4
    s_and_b32 s97, s97, 7
    s_add_u32 m0, s61, 0
    s_mul_i32 s97, s97, 196608
    buffer_load_dwordx4 v166, s[28:31], s97 offen lds
    buffer_load_dwordx4 v167, s[28:31], s97 offen offset:1024 lds
    buffer_load_dwordx4 v168, s[28:31], s97 offen offset:2048 lds
    buffer_load_dwordx4 v169, s[28:31], s97 offen offset:3072 lds
    s_waitcnt lgkmcnt(0)
    s_mov_b32 s3, 0x40000
    v_cmp_ne_u64 vcc, 0, v[6:7]
    s_nop 1
    s_cmp_eq_u64 vcc, -1
    s_cbranch_scc1 L_pokH0
L_pspinH0:
    buffer_load_dwordx2 v[6:7], off, s[48:51], 0 sc1
    s_sub_u32 s3, s3, 1
    s_cbranch_scc1 L_pokH0
    s_waitcnt vmcnt(0)
    v_cmp_ne_u64 vcc, 0, v[6:7]
    s_nop 2
    s_cmp_eq_u64 vcc, -1
    s_cbranch_scc0 L_pspinH0
L_pokH0:
    v_readfirstlane_b32 s26, v6
    v_readfirstlane_b32 s27, v7
    s_waitcnt vmcnt(12)
    s_barrier
    s_add_u32 s97, s55, 5
    s_and_b32 s97, s97, 7
    s_add_u32 m0, s61, 16384
    s_mul_i32 s97, s97, 196608
    buffer_load_dwordx4 v166, s[28:31], s97 offen lds
    buffer_load_dwordx4 v167, s[28:31], s97 offen offset:1024 lds
    buffer_load_dwordx4 v168, s[28:31], s97 offen offset:2048 lds
    buffer_load_dwordx4 v169, s[28:31], s97 offen offset:3072 lds
    s_waitcnt vmcnt(12)
    s_barrier
    s_add_u32 s97, s55, 6
    s_and_b32 s97, s97, 7
    s_add_u32 m0, s61, 32768
    s_mul_i32 s97, s97, 196608
    buffer_load_dwordx4 v166, s[28:31], s97 offen lds
    buffer_load_dwordx4 v167, s[28:31], s97 offen offset:1024 lds
    buffer_load_dwordx4 v168, s[28:31], s97 offen offset:2048 lds
    buffer_load_dwordx4 v169, s[28:31], s97 offen offset:3072 lds
    s_waitcnt vmcnt(12)
    s_barrier
    v_mul_u32_u24 v0, 56, v1
    v_add_u32 v0, 88, v0
    s_sub_u32 s63, 31, s54
    s_min_u32 s63, s63, 4
    v_cmp_gt_u32 vcc, s63, v1
    s_cmp_eq_u32 s54, 0
    s_cselect_b32 s63, 24, 2147483648
    v_mov_b32 v5, s63
    v_cndmask_b32 v0, v5, v0, vcc
    s_lshl_b32 s60, s56, 5
    s_add_u32 s60, s60, s54
    s_lshl_b32 s60, s60, 6
    s_add_u32 s60, s60, 9437184
    buffer_store_dwordx2 v[6:7], v0, s[32:35], s60 offen sc1
    s_add_u32 s97, s55, 7
    s_and_b32 s97, s97, 7
    s_add_u32 m0, s61, 49152
    s_mul_i32 s97, s97, 196608
    buffer_load_dwordx4 v166, s[28:31], s97 offen lds
    buffer_load_dwordx4 v167, s[28:31], s97 offen offset:1024 lds
    buffer_load_dwordx4 v168, s[28:31], s97 offen offset:2048 lds
    buffer_load_dwordx4 v169, s[28:31], s97 offen offset:3072 lds
    s_mov_b32 s36, s8
    s_mov_b32 s37, s9
    s_mov_b32 s38, 524288
    s_mov_b32 s39, 0x20000
    s_mov_b32 s40, s14
    s_mov_b32 s41, s15
    s_mov_b32 s42, 524288
    s_mov_b32 s43, 0x20000
    s_mov_b32 s44, s18
    s_mov_b32 s45, s19
    s_mov_b32 s46, 2097152
    s_mov_b32 s47, 0x20000
    s_waitcnt vmcnt(13)
    s_barrier
    v_lshrrev_b32 v48, 3, v1
    v_bfe_u32 v49, v1, 4, 1
    v_lshlrev_b32 v49, 2, v49
    v_and_b32 v50, 7, v1
    v_xor_b32 v49, v49, v50
    v_lshlrev_b32 v49, 4, v49
    v_lshl_add_u32 v160, v48, 10, v49
    v_and_b32 v161, 32, v1
    v_lshlrev_b32 v161, 4, v161
    v_mul_u32_u24 v162, 8320, v50
    v_bfe_u32 v51, v1, 3, 1
    v_lshl_add_u32 v162, v51, 4, v162
    s_mul_i32 s61, s52, 2080
    s_add_u32 s61, s61, 65536
    s_add_u32 s60, s61, 2048
    v_add_u32 v162, s60, v162
    s_lshl_b32 s60, s54, 1
    v_add_u32 v48, s60, v50
    v_cmp_le_u32 vcc, 8, v48
    v_mov_b32 v49, 0x3f803f80
    s_nop 0
    v_cndmask_b32 v164, 0, v49, vcc
    v_subrev_u32 v51, 1, v51
    v_and_b32 v164, v51, v164
    v_mov_b32 v165, v164
    v_mov_b32 v166, v164
    v_mov_b32 v167, v164
    s_mul_i32 s30, s52, 6144
    s_add_u32 s30, s30, 132096
    s_mul_i32 s31, s52, 10240
    s_add_u32 s31, s31, 59392
    s_lshl_b32 s59, s56, 5
    s_add_u32 s59, s59, s54
    s_lshl_b32 s59, s59, 6
    s_add_u32 s59, s59, 9437184
    s_waitcnt vmcnt(9)
    s_barrier
    s_load_dwordx8 s[4:11], s[22:23], s59 glc
    v_mov_b32 v172, -1
    v_mov_b32 v173, -1
    v_mov_b32 v174, -1
    v_mov_b32 v175, -1
    s_lshl_b32 s60, s54, 17
    s_lshl_b32 s63, s56, 10
    s_add_u32 s60, s60, s63
    s_add_u32 s60, s60, 5275648
    buffer_store_dwordx4 v[172:175], v2, s[32:35], s60 offen sc1
    s_lshl_b32 s60, s54, 17
    s_lshl_b32 s63, s56, 10
    s_add_u32 s60, s60, s63
    s_add_u32 s60, s60, 5242880
    buffer_store_dwordx4 v[172:175], v2, s[32:35], s60 offen sc1
    s_waitcnt vmcnt(7)
    s_barrier
    s_waitcnt lgkmcnt(0)
    s_mov_b32 s3, 0x40000
L_spH1:
    s_cmp_lt_u32 s54, 4
    s_cselect_b64 s[4:5], s[26:27], s[4:5]
    s_cmp_lt_u32 s54, 3
    s_cselect_b64 s[6:7], s[26:27], s[6:7]
    s_cmp_lt_u32 s54, 2
    s_cselect_b64 s[8:9], s[26:27], s[8:9]
    s_xor_b64 s[4:5], s[4:5], s[26:27]
    s_xor_b64 s[6:7], s[6:7], s[26:27]
    s_or_b64 s[4:5], s[4:5], s[6:7]
    s_xor_b64 s[8:9], s[8:9], s[26:27]
    s_or_b64 s[4:5], s[4:5], s[8:9]
    s_xor_b64 s[10:11], s[10:11], s[26:27]
    s_or_b64 s[4:5], s[4:5], s[10:11]
    s_cmp_eq_u64 s[4:5], 0
    s_cbranch_scc1 L_spokH1
    s_load_dwordx8 s[4:11], s[22:23], s59 glc
    s_sub_u32 s3, s3, 1
    s_waitcnt lgkmcnt(0)
    s_cbranch_scc0 L_spH1
L_spokH1:
    s_waitcnt vmcnt(2)
    s_barrier
    ds_write_b128 v162, v[164:167]
    s_cmp_lt_u32 s54, 4
    s_cbranch_scc1 L_gspecial0
    s_lshl_b32 s59, s56, 17
    s_lshl_b32 s63, s54, 12
    s_add_u32 s96, s59, s63
    s_sub_u32 s96, s96, 16384
    s_add_u32 s60, s96, 0
    s_add_u32 m0, s61, 0
    s_nop 0
    buffer_load_dwordx4 v2, s[32:35], s60 offen sc1 lds
    buffer_load_dwordx4 v2, s[32:35], s60 offen offset:1024 sc1 lds
    s_add_u32 s60, s96, 2048
    s_add_u32 m0, s61, 8320
    s_nop 0
    buffer_load_dwordx4 v2, s[32:35], s60 offen sc1 lds
    buffer_load_dwordx4 v2, s[32:35], s60 offen offset:1024 sc1 lds
L_gdone0:
    s_barrier
    s_setprio 2
    s_cmp_lt_u32 s54, 4
    s_cbranch_scc1 L_gspecial1
    s_add_u32 s60, s96, 4096
    s_add_u32 m0, s61, 16640
    s_nop 0
    buffer_load_dwordx4 v2, s[32:35], s60 offen sc1 lds
    buffer_load_dwordx4 v2, s[32:35], s60 offen offset:1024 sc1 lds
    s_add_u32 s60, s96, 6144
    s_add_u32 m0, s61, 24960
    s_nop 0
    buffer_load_dwordx4 v2, s[32:35], s60 offen sc1 lds
    buffer_load_dwordx4 v2, s[32:35], s60 offen offset:1024 sc1 lds
    s_add_u32 s60, s96, 8192
    s_add_u32 m0, s61, 33280
    s_nop 0
    buffer_load_dwordx4 v2, s[32:35], s60 offen sc1 lds
    buffer_load_dwordx4 v2, s[32:35], s60 offen offset:1024 sc1 lds
    s_add_u32 s60, s96, 10240
    s_add_u32 m0, s61, 41600
    s_nop 0
    buffer_load_dwordx4 v2, s[32:35], s60 offen sc1 lds
    buffer_load_dwordx4 v2, s[32:35], s60 offen offset:1024 sc1 lds
    s_add_u32 s60, s96, 12288
    s_add_u32 m0, s61, 49920
    s_nop 0
    buffer_load_dwordx4 v2, s[32:35], s60 offen sc1 lds
    buffer_load_dwordx4 v2, s[32:35], s60 offen offset:1024 sc1 lds
    s_add_u32 s60, s96, 14336
    s_add_u32 m0, s61, 58240
    s_nop 0
    buffer_load_dwordx4 v2, s[32:35], s60 offen sc1 lds
    buffer_load_dwordx4 v2, s[32:35], s60 offen offset:1024 sc1 lds
L_gdone1:
    s_add_u32 m0, s62, 0
    s_add_u32 s97, s25, 0
    buffer_load_dwordx4 v160, s[40:43], s97 offen lds
    s_add_u32 m0, s62, 1024
    s_add_u32 s97, s25, 8192
    buffer_load_dwordx4 v160, s[40:43], s97 offen lds
    s_add_u32 m0, s62, 2048
    s_add_u32 s97, s25, 16384
    buffer_load_dwordx4 v160, s[40:43], s97 offen lds
    s_add_u32 m0, s62, 3072
    s_add_u32 s97, s25, 24576
    buffer_load_dwordx4 v160, s[40:43], s97 offen lds
    s_waitcnt vmcnt(4)
    s_waitcnt lgkmcnt(0)
    s_barrier
    s_add_u32 m0, s62, 4096
    s_add_u32 s97, s25, 32768
    buffer_load_dwordx4 v160, s[40:43], s97 offen lds
    s_add_u32 m0, s62, 5120
    s_add_u32 s97, s25, 40960
    buffer_load_dwordx4 v160, s[40:43], s97 offen lds
    s_add_u32 m0, s62, 6144
    s_add_u32 s97, s25, 49152
    buffer_load_dwordx4 v160, s[40:43], s97 offen lds
    s_add_u32 m0, s62, 7168
    s_add_u32 s97, s25, 57344
    buffer_load_dwordx4 v160, s[40:43], s97 offen lds
    s_add_u32 m0, s62, 8192
    s_add_u32 s97, s25, 65536
    buffer_load_dwordx4 v160, s[40:43], s97 offen lds
    s_add_u32 m0, s62, 9216
    s_add_u32 s97, s25, 73728
    buffer_load_dwordx4 v160, s[40:43], s97 offen lds
    s_add_u32 m0, s62, 10240
    s_add_u32 s97, s25, 81920
    buffer_load_dwordx4 v160, s[40:43], s97 offen lds
    s_add_u32 m0, s62, 11264
    s_add_u32 s97, s25, 90112
    buffer_load_dwordx4 v160, s[40:43], s97 offen lds
    s_add_u32 m0, s62, 12288
    s_add_u32 s97, s25, 98304
    buffer_load_dwordx4 v160, s[40:43], s97 offen lds
    s_add_u32 m0, s62, 13312
    s_add_u32 s97, s25, 106496
    buffer_load_dwordx4 v160, s[40:43], s97 offen lds
    s_add_u32 m0, s62, 14336
    s_add_u32 s97, s25, 114688
    buffer_load_dwordx4 v160, s[40:43], s97 offen lds
    s_add_u32 m0, s62, 15360
    s_add_u32 s97, s25, 122880
    buffer_load_dwordx4 v160, s[40:43], s97 offen lds
    s_add_u32 m0, s30, 0
    s_add_u32 s97, s25, 0
    buffer_load_dwordx4 v160, s[36:39], s97 offen lds
    s_add_u32 m0, s30, 1024
    s_add_u32 s97, s25, 8192
    buffer_load_dwordx4 v160, s[36:39], s97 offen lds
    s_add_u32 m0, s30, 2048
    s_add_u32 s97, s25, 16384
    buffer_load_dwordx4 v160, s[36:39], s97 offen lds
    s_add_u32 m0, s30, 3072
    s_add_u32 s97, s25, 24576
    buffer_load_dwordx4 v160, s[36:39], s97 offen lds
    s_add_u32 m0, s30, 4096
    s_add_u32 s97, s25, 32768
    buffer_load_dwordx4 v160, s[36:39], s97 offen lds
    s_add_u32 m0, s30, 5120
    s_add_u32 s97, s25, 40960
    buffer_load_dwordx4 v160, s[36:39], s97 offen lds
    s_barrier
    v_lshlrev_b32 v0, 8, v1
    v_cmp_gt_u32 vcc, 8, v1
    v_mov_b32 v5, 2147483648
    s_nop 0
    v_cndmask_b32 v0, v5, v0, vcc
    s_lshl_b32 s60, s54, 8
    s_add_u32 s60, s60, s56
    s_lshl_b32 s60, s60, 3
    s_add_u32 s60, s60, 9502720
    buffer_store_dwordx2 v[6:7], v0, s[32:35], s60 offen sc1
    s_add_u32 s59, s24, 9502720
    s_waitcnt vmcnt(7)
    s_barrier
    s_add_u32 m0, s31, 6144
    s_add_u32 s97, s25, 49152
    buffer_load_dwordx4 v160, s[36:39], s97 offen lds
    s_add_u32 m0, s31, 7168
    s_add_u32 s97, s25, 57344
    buffer_load_dwordx4 v160, s[36:39], s97 offen lds
    s_add_u32 m0, s31, 8192
    s_add_u32 s97, s25, 65536
    buffer_load_dwordx4 v160, s[36:39], s97 offen lds
    s_add_u32 m0, s31, 9216
    s_add_u32 s97, s25, 73728
    buffer_load_dwordx4 v160, s[36:39], s97 offen lds
    s_add_u32 m0, s31, 10240
    s_add_u32 s97, s25, 81920
    buffer_load_dwordx4 v160, s[36:39], s97 offen lds
    s_load_dwordx16 s[4:19], s[22:23], s59 glc
    s_load_dwordx16 s[64:79], s[22:23], s59 offset:64 glc
    s_add_u32 m0, s31, 11264
    s_add_u32 s97, s25, 90112
    buffer_load_dwordx4 v160, s[36:39], s97 offen lds
    s_add_u32 m0, s31, 12288
    s_add_u32 s97, s25, 98304
    buffer_load_dwordx4 v160, s[36:39], s97 offen lds
    s_add_u32 m0, s31, 13312
    s_add_u32 s97, s25, 106496
    buffer_load_dwordx4 v160, s[36:39], s97 offen lds
    s_add_u32 m0, s31, 14336
    s_add_u32 s97, s25, 114688
    buffer_load_dwordx4 v160, s[36:39], s97 offen lds
    s_add_u32 m0, s31, 15360
    s_add_u32 s97, s25, 122880
    buffer_load_dwordx4 v160, s[36:39], s97 offen lds
    s_waitcnt lgkmcnt(0)
    s_mov_b32 s3, 0x40000
L_spH2:
    s_xor_b64 s[4:5], s[4:5], s[26:27]
    s_xor_b64 s[6:7], s[6:7], s[26:27]
    s_or_b64 s[4:5], s[4:5], s[6:7]
    s_xor_b64 s[8:9], s[8:9], s[26:27]
    s_or_b64 s[4:5], s[4:5], s[8:9]
    s_xor_b64 s[10:11], s[10:11], s[26:27]
    s_or_b64 s[4:5], s[4:5], s[10:11]
    s_xor_b64 s[12:13], s[12:13], s[26:27]
    s_or_b64 s[4:5], s[4:5], s[12:13]
    s_xor_b64 s[14:15], s[14:15], s[26:27]
    s_or_b64 s[4:5], s[4:5], s[14:15]
    s_xor_b64 s[16:17], s[16:17], s[26:27]
    s_or_b64 s[4:5], s[4:5], s[16:17]
    s_xor_b64 s[18:19], s[18:19], s[26:27]
    s_or_b64 s[4:5], s[4:5], s[18:19]
    s_xor_b64 s[64:65], s[64:65], s[26:27]
    s_or_b64 s[4:5], s[4:5], s[64:65]
    s_xor_b64 s[66:67], s[66:67], s[26:27]
    s_or_b64 s[4:5], s[4:5], s[66:67]
    s_xor_b64 s[68:69], s[68:69], s[26:27]
    s_or_b64 s[4:5], s[4:5], s[68:69]
    s_xor_b64 s[70:71], s[70:71], s[26:27]
    s_or_b64 s[4:5], s[4:5], s[70:71]
    s_xor_b64 s[72:73], s[72:73], s[26:27]
    s_or_b64 s[4:5], s[4:5], s[72:73]
    s_xor_b64 s[74:75], s[74:75], s[26:27]
    s_or_b64 s[4:5], s[4:5], s[74:75]
    s_xor_b64 s[76:77], s[76:77], s[26:27]
    s_or_b64 s[4:5], s[4:5], s[76:77]
    s_xor_b64 s[78:79], s[78:79], s[26:27]
    s_or_b64 s[4:5], s[4:5], s[78:79]
    s_cmp_eq_u64 s[4:5], 0
    s_cbranch_scc1 L_spokH2
    s_load_dwordx16 s[4:19], s[22:23], s59 glc
    s_load_dwordx16 s[64:79], s[22:23], s59 offset:64 glc
    s_sub_u32 s3, s3, 1
    s_waitcnt lgkmcnt(0)
    s_cbranch_scc0 L_spH2
L_spokH2:
    s_mov_b32 s63, 65536
    buffer_load_dwordx4 v[96:99], v18, s[32:35], s63 offen sc1
    buffer_load_dwordx4 v[100:103], v18, s[32:35], s63 offen offset:1024 sc1
    buffer_load_dwordx4 v[104:107], v18, s[32:35], s63 offen offset:2048 sc1
    buffer_load_dwordx4 v[108:111], v18, s[32:35], s63 offen offset:3072 sc1
    s_mov_b32 s63, 69632
    buffer_load_dwordx4 v[112:115], v18, s[32:35], s63 offen sc1
    buffer_load_dwordx4 v[116:119], v18, s[32:35], s63 offen offset:1024 sc1
    buffer_load_dwordx4 v[120:123], v18, s[32:35], s63 offen offset:2048 sc1
    buffer_load_dwordx4 v[124:127], v18, s[32:35], s63 offen offset:3072 sc1
    s_mov_b32 s63, 73728
    buffer_load_dwordx4 v[128:131], v18, s[32:35], s63 offen sc1
    buffer_load_dwordx4 v[132:135], v18, s[32:35], s63 offen offset:1024 sc1
    buffer_load_dwordx4 v[136:139], v18, s[32:35], s63 offen offset:2048 sc1
    buffer_load_dwordx4 v[140:143], v18, s[32:35], s63 offen offset:3072 sc1
    s_mov_b32 s63, 77824
    buffer_load_dwordx4 v[144:147], v18, s[32:35], s63 offen sc1
    buffer_load_dwordx4 v[148:151], v18, s[32:35], s63 offen offset:1024 sc1
    buffer_load_dwordx4 v[152:155], v18, s[32:35], s63 offen offset:2048 sc1
    buffer_load_dwordx4 v[156:159], v18, s[32:35], s63 offen offset:3072 sc1
    s_setprio 0
    ds_read_b64_tr_b16 v[176:177], v16 offset:0
    ds_read_b64_tr_b16 v[178:179], v16 offset:1024
    ds_read_b64_tr_b16 v[180:181], v17 offset:0
    ds_read_b64_tr_b16 v[182:183], v17 offset:1024
    s_waitcnt vmcnt(15) lgkmcnt(2)
    v_mfma_f32_32x32x16_bf16 v[32:47], v[176:179], v[96:99], 0
    ds_read_b64_tr_b16 v[184:185], v16 offset:2048
    ds_read_b64_tr_b16 v[186:187], v16 offset:3072
    s_waitcnt lgkmcnt(2)
    v_mfma_f32_32x32x16_bf16 v[48:63], v[180:183], v[96:99], 0
    ds_read_b64_tr_b16 v[188:189], v17 offset:2048
    ds_read_b64_tr_b16 v[190:191], v17 offset:3072
    s_waitcnt vmcnt(14) lgkmcnt(2)
    v_mfma_f32_32x32x16_bf16 v[32:47], v[184:187], v[100:103], v[32:47]
    ds_read_b64_tr_b16 v[176:177], v16 offset:4096
    ds_read_b64_tr_b16 v[178:179], v16 offset:5120
    s_waitcnt lgkmcnt(2)
    v_mfma_f32_32x32x16_bf16 v[48:63], v[188:191], v[100:103], v[48:63]
    ds_read_b64_tr_b16 v[180:181], v17 offset:4096
    ds_read_b64_tr_b16 v[182:183], v17 offset:5120
    s_waitcnt vmcnt(13) lgkmcnt(2)
    v_mfma_f32_32x32x16_bf16 v[32:47], v[176:179], v[104:107], v[32:47]
    ds_read_b64_tr_b16 v[184:185], v16 offset:6144
    ds_read_b64_tr_b16 v[186:187], v16 offset:7168
    s_waitcnt lgkmcnt(2)
    v_mfma_f32_32x32x16_bf16 v[48:63], v[180:183], v[104:107], v[48:63]
    ds_read_b64_tr_b16 v[188:189], v17 offset:6144
    ds_read_b64_tr_b16 v[190:191], v17 offset:7168
    s_waitcnt vmcnt(12) lgkmcnt(2)
    v_mfma_f32_32x32x16_bf16 v[32:47], v[184:187], v[108:111], v[32:47]
    ds_read_b64_tr_b16 v[176:177], v16 offset:8192
    ds_read_b64_tr_b16 v[178:179], v16 offset:9216
    s_waitcnt lgkmcnt(2)
    v_mfma_f32_32x32x16_bf16 v[48:63], v[188:191], v[108:111], v[48:63]
    ds_read_b64_tr_b16 v[180:181], v17 offset:8192
    ds_read_b64_tr_b16 v[182:183], v17 offset:9216
    s_waitcnt vmcnt(11) lgkmcnt(2)
    v_mfma_f32_32x32x16_bf16 v[32:47], v[176:179], v[112:115], v[32:47]
    ds_read_b64_tr_b16 v[184:185], v16 offset:10240
    ds_read_b64_tr_b16 v[186:187], v16 offset:11264
    s_waitcnt lgkmcnt(2)
    v_mfma_f32_32x32x16_bf16 v[48:63], v[180:183], v[112:115], v[48:63]
    ds_read_b64_tr_b16 v[188:189], v17 offset:10240
    ds_read_b64_tr_b16 v[190:191], v17 offset:11264
    s_waitcnt vmcnt(10) lgkmcnt(2)
    v_mfma_f32_32x32x16_bf16 v[32:47], v[184:187], v[116:119], v[32:47]
    ds_read_b64_tr_b16 v[176:177], v16 offset:12288
    ds_read_b64_tr_b16 v[178:179], v16 offset:13312
    s_waitcnt lgkmcnt(2)
    v_mfma_f32_32x32x16_bf16 v[48:63], v[188:191], v[116:119], v[48:63]
    ds_read_b64_tr_b16 v[180:181], v17 offset:12288
    ds_read_b64_tr_b16 v[182:183], v17 offset:13312
    s_waitcnt vmcnt(9) lgkmcnt(2)
    v_mfma_f32_32x32x16_bf16 v[32:47], v[176:179], v[120:123], v[32:47]
    ds_read_b64_tr_b16 v[184:185], v16 offset:14336
    ds_read_b64_tr_b16 v[186:187], v16 offset:15360
    s_waitcnt lgkmcnt(2)
    v_mfma_f32_32x32x16_bf16 v[48:63], v[180:183], v[120:123], v[48:63]
    ds_read_b64_tr_b16 v[188:189], v17 offset:14336
    ds_read_b64_tr_b16 v[190:191], v17 offset:15360
    s_waitcnt vmcnt(8) lgkmcnt(2)
    v_mfma_f32_32x32x16_bf16 v[32:47], v[184:187], v[124:127], v[32:47]
    ds_read_b64_tr_b16 v[176:177], v16 offset:16384
    ds_read_b64_tr_b16 v[178:179], v16 offset:17408
    s_waitcnt lgkmcnt(2)
    v_mfma_f32_32x32x16_bf16 v[48:63], v[188:191], v[124:127], v[48:63]
    ds_read_b64_tr_b16 v[180:181], v17 offset:16384
    ds_read_b64_tr_b16 v[182:183], v17 offset:17408
    s_waitcnt vmcnt(7) lgkmcnt(2)
    v_mfma_f32_32x32x16_bf16 v[32:47], v[176:179], v[128:131], v[32:47]
    ds_read_b64_tr_b16 v[184:185], v16 offset:18432
    ds_read_b64_tr_b16 v[186:187], v16 offset:19456
    s_waitcnt lgkmcnt(2)
    v_mfma_f32_32x32x16_bf16 v[48:63], v[180:183], v[128:131], v[48:63]
    ds_read_b64_tr_b16 v[188:189], v17 offset:18432
    ds_read_b64_tr_b16 v[190:191], v17 offset:19456
    s_waitcnt vmcnt(6) lgkmcnt(2)
    v_mfma_f32_32x32x16_bf16 v[32:47], v[184:187], v[132:135], v[32:47]
    ds_read_b64_tr_b16 v[176:177], v16 offset:20480
    ds_read_b64_tr_b16 v[178:179], v16 offset:21504
    s_waitcnt lgkmcnt(2)
    v_mfma_f32_32x32x16_bf16 v[48:63], v[188:191], v[132:135], v[48:63]
    ds_read_b64_tr_b16 v[180:181], v17 offset:20480
    ds_read_b64_tr_b16 v[182:183], v17 offset:21504
    s_waitcnt vmcnt(5) lgkmcnt(2)
    v_mfma_f32_32x32x16_bf16 v[32:47], v[176:179], v[136:139], v[32:47]
    ds_read_b64_tr_b16 v[184:185], v16 offset:22528
    ds_read_b64_tr_b16 v[186:187], v16 offset:23552
    s_waitcnt lgkmcnt(2)
    v_mfma_f32_32x32x16_bf16 v[48:63], v[180:183], v[136:139], v[48:63]
    ds_read_b64_tr_b16 v[188:189], v17 offset:22528
    ds_read_b64_tr_b16 v[190:191], v17 offset:23552
    s_waitcnt vmcnt(4) lgkmcnt(2)
    v_mfma_f32_32x32x16_bf16 v[32:47], v[184:187], v[140:143], v[32:47]
    ds_read_b64_tr_b16 v[176:177], v16 offset:24576
    ds_read_b64_tr_b16 v[178:179], v16 offset:25600
    s_waitcnt lgkmcnt(2)
    v_mfma_f32_32x32x16_bf16 v[48:63], v[188:191], v[140:143], v[48:63]
    ds_read_b64_tr_b16 v[180:181], v17 offset:24576
    ds_read_b64_tr_b16 v[182:183], v17 offset:25600
    s_waitcnt vmcnt(3) lgkmcnt(2)
    v_mfma_f32_32x32x16_bf16 v[32:47], v[176:179], v[144:147], v[32:47]
    ds_read_b64_tr_b16 v[184:185], v16 offset:26624
    ds_read_b64_tr_b16 v[186:187], v16 offset:27648
    s_waitcnt lgkmcnt(2)
    v_mfma_f32_32x32x16_bf16 v[48:63], v[180:183], v[144:147], v[48:63]
    ds_read_b64_tr_b16 v[188:189], v17 offset:26624
    ds_read_b64_tr_b16 v[190:191], v17 offset:27648
    s_waitcnt vmcnt(2) lgkmcnt(2)
    v_mfma_f32_32x32x16_bf16 v[32:47], v[184:187], v[148:151], v[32:47]
    ds_read_b64_tr_b16 v[176:177], v16 offset:28672
    ds_read_b64_tr_b16 v[178:179], v16 offset:29696
    s_waitcnt lgkmcnt(2)
    v_mfma_f32_32x32x16_bf16 v[48:63], v[188:191], v[148:151], v[48:63]
    ds_read_b64_tr_b16 v[180:181], v17 offset:28672
    ds_read_b64_tr_b16 v[182:183], v17 offset:29696
    s_waitcnt vmcnt(1) lgkmcnt(2)
    v_mfma_f32_32x32x16_bf16 v[32:47], v[176:179], v[152:155], v[32:47]
    ds_read_b64_tr_b16 v[184:185], v16 offset:30720
    ds_read_b64_tr_b16 v[186:187], v16 offset:31744
    s_waitcnt lgkmcnt(2)
    v_mfma_f32_32x32x16_bf16 v[48:63], v[180:183], v[152:155], v[48:63]
    ds_read_b64_tr_b16 v[188:189], v17 offset:30720
    ds_read_b64_tr_b16 v[190:191], v17 offset:31744
    s_waitcnt vmcnt(0) lgkmcnt(0)
    v_mfma_f32_32x32x16_bf16 v[48:63], v[188:191], v[156:159], v[48:63]
    v_mfma_f32_32x32x16_bf16 v[32:47], v[184:187], v[156:159], v[32:47]
    s_barrier
    s_mov_b32 s63, 0
    buffer_load_dwordx4 v[192:195], v18, s[32:35], s63 offen sc1
    buffer_load_dwordx4 v[196:199], v18, s[32:35], s63 offen offset:1024 sc1
    buffer_load_dwordx4 v[200:203], v18, s[32:35], s63 offen offset:2048 sc1
    buffer_load_dwordx4 v[204:207], v18, s[32:35], s63 offen offset:3072 sc1
    s_mov_b32 s63, 4096
    buffer_load_dwordx4 v[208:211], v18, s[32:35], s63 offen sc1
    buffer_load_dwordx4 v[212:215], v18, s[32:35], s63 offen offset:1024 sc1
    buffer_load_dwordx4 v[216:219], v18, s[32:35], s63 offen offset:2048 sc1
    buffer_load_dwordx4 v[220:223], v18, s[32:35], s63 offen offset:3072 sc1
    s_mov_b32 s63, 8192
    buffer_load_dwordx4 v[224:227], v18, s[32:35], s63 offen sc1
    buffer_load_dwordx4 v[228:231], v18, s[32:35], s63 offen offset:1024 sc1
    buffer_load_dwordx4 v[232:235], v18, s[32:35], s63 offen offset:2048 sc1
    buffer_load_dwordx4 v[236:239], v18, s[32:35], s63 offen offset:3072 sc1
    s_mov_b32 s63, 12288
    buffer_load_dwordx4 v[240:243], v18, s[32:35], s63 offen sc1
    buffer_load_dwordx4 v[244:247], v18, s[32:35], s63 offen offset:1024 sc1
    buffer_load_dwordx4 v[248:251], v18, s[32:35], s63 offen offset:2048 sc1
    buffer_load_dwordx4 v[252:255], v18, s[32:35], s63 offen offset:3072 sc1
    ds_read_b64_tr_b16 v[176:177], v24 offset:0
    ds_read_b64_tr_b16 v[178:179], v24 offset:1024
    ds_read_b64_tr_b16 v[180:181], v25 offset:0
    ds_read_b64_tr_b16 v[182:183], v25 offset:1024
    s_waitcnt vmcnt(15) lgkmcnt(2)
    v_mfma_f32_32x32x16_bf16 v[64:79], v[176:179], v[192:195], v[32:47]
    ds_read_b64_tr_b16 v[184:185], v24 offset:2048
    ds_read_b64_tr_b16 v[186:187], v24 offset:3072
    s_waitcnt lgkmcnt(2)
    v_mfma_f32_32x32x16_bf16 v[80:95], v[180:183], v[192:195], v[48:63]
    ds_read_b64_tr_b16 v[188:189], v25 offset:2048
    ds_read_b64_tr_b16 v[190:191], v25 offset:3072
    v_max3_u32 v28, v192, v193, v193
    v_max3_u32 v28, v28, v194, v195
    s_waitcnt vmcnt(14) lgkmcnt(2)
    v_mfma_f32_32x32x16_bf16 v[64:79], v[184:187], v[196:199], v[64:79]
    ds_read_b64_tr_b16 v[176:177], v24 offset:4096
    ds_read_b64_tr_b16 v[178:179], v24 offset:5120
    s_waitcnt lgkmcnt(2)
    v_mfma_f32_32x32x16_bf16 v[80:95], v[188:191], v[196:199], v[80:95]
    ds_read_b64_tr_b16 v[180:181], v25 offset:4096
    ds_read_b64_tr_b16 v[182:183], v25 offset:5120
    v_max3_u32 v28, v28, v196, v197
    v_max3_u32 v28, v28, v198, v199
    s_waitcnt vmcnt(13) lgkmcnt(2)
    v_mfma_f32_32x32x16_bf16 v[64:79], v[176:179], v[200:203], v[64:79]
    ds_read_b64_tr_b16 v[184:185], v26 offset:0
    ds_read_b64_tr_b16 v[186:187], v26 offset:1024
    s_waitcnt lgkmcnt(2)
    v_mfma_f32_32x32x16_bf16 v[80:95], v[180:183], v[200:203], v[80:95]
    ds_read_b64_tr_b16 v[188:189], v27 offset:0
    ds_read_b64_tr_b16 v[190:191], v27 offset:1024
    v_max3_u32 v28, v28, v200, v201
    v_max3_u32 v28, v28, v202, v203
    s_waitcnt vmcnt(12) lgkmcnt(2)
    v_mfma_f32_32x32x16_bf16 v[64:79], v[184:187], v[204:207], v[64:79]
    ds_read_b64_tr_b16 v[176:177], v26 offset:2048
    ds_read_b64_tr_b16 v[178:179], v26 offset:3072
    s_waitcnt lgkmcnt(2)
    v_mfma_f32_32x32x16_bf16 v[80:95], v[188:191], v[204:207], v[80:95]
    ds_read_b64_tr_b16 v[180:181], v27 offset:2048
    ds_read_b64_tr_b16 v[182:183], v27 offset:3072
    v_max3_u32 v28, v28, v204, v205
    v_max3_u32 v28, v28, v206, v207
    s_waitcnt vmcnt(11) lgkmcnt(2)
    v_mfma_f32_32x32x16_bf16 v[64:79], v[176:179], v[208:211], v[64:79]
    ds_read_b64_tr_b16 v[184:185], v26 offset:4096
    ds_read_b64_tr_b16 v[186:187], v26 offset:5120
    s_waitcnt lgkmcnt(2)
    v_mfma_f32_32x32x16_bf16 v[80:95], v[180:183], v[208:211], v[80:95]
    ds_read_b64_tr_b16 v[188:189], v27 offset:4096
    ds_read_b64_tr_b16 v[190:191], v27 offset:5120
    v_max3_u32 v28, v28, v208, v209
    v_max3_u32 v28, v28, v210, v211
    s_waitcnt vmcnt(10) lgkmcnt(2)
    v_mfma_f32_32x32x16_bf16 v[64:79], v[184:187], v[212:215], v[64:79]
    ds_read_b64_tr_b16 v[176:177], v26 offset:6144
    ds_read_b64_tr_b16 v[178:179], v26 offset:7168
    s_waitcnt lgkmcnt(2)
    v_mfma_f32_32x32x16_bf16 v[80:95], v[188:191], v[212:215], v[80:95]
    ds_read_b64_tr_b16 v[180:181], v27 offset:6144
    ds_read_b64_tr_b16 v[182:183], v27 offset:7168
    v_max3_u32 v28, v28, v212, v213
    v_max3_u32 v28, v28, v214, v215
    s_waitcnt vmcnt(9) lgkmcnt(2)
    v_mfma_f32_32x32x16_bf16 v[64:79], v[176:179], v[216:219], v[64:79]
    ds_read_b64_tr_b16 v[184:185], v26 offset:8192
    ds_read_b64_tr_b16 v[186:187], v26 offset:9216
    s_waitcnt lgkmcnt(2)
    v_mfma_f32_32x32x16_bf16 v[80:95], v[180:183], v[216:219], v[80:95]
    ds_read_b64_tr_b16 v[188:189], v27 offset:8192
    ds_read_b64_tr_b16 v[190:191], v27 offset:9216
    v_max3_u32 v28, v28, v216, v217
    v_max3_u32 v28, v28, v218, v219
    s_waitcnt vmcnt(8) lgkmcnt(2)
    v_mfma_f32_32x32x16_bf16 v[64:79], v[184:187], v[220:223], v[64:79]
    ds_read_b64_tr_b16 v[176:177], v24 offset:6144
    ds_read_b64_tr_b16 v[178:179], v24 offset:7168
    s_waitcnt lgkmcnt(2)
    v_mfma_f32_32x32x16_bf16 v[80:95], v[188:191], v[220:223], v[80:95]
    ds_read_b64_tr_b16 v[180:181], v25 offset:6144
    ds_read_b64_tr_b16 v[182:183], v25 offset:7168
    v_max3_u32 v28, v28, v220, v221
    v_max3_u32 v28, v28, v222, v223
    s_waitcnt vmcnt(7) lgkmcnt(2)
    v_mfma_f32_32x32x16_bf16 v[64:79], v[176:179], v[224:227], v[64:79]
    ds_read_b64_tr_b16 v[184:185], v24 offset:8192
    ds_read_b64_tr_b16 v[186:187], v24 offset:9216
    s_waitcnt lgkmcnt(2)
    v_mfma_f32_32x32x16_bf16 v[80:95], v[180:183], v[224:227], v[80:95]
    ds_read_b64_tr_b16 v[188:189], v25 offset:8192
    ds_read_b64_tr_b16 v[190:191], v25 offset:9216
    v_max3_u32 v28, v28, v224, v225
    v_max3_u32 v28, v28, v226, v227
    s_waitcnt vmcnt(6) lgkmcnt(2)
    v_mfma_f32_32x32x16_bf16 v[64:79], v[184:187], v[228:231], v[64:79]
    ds_read_b64_tr_b16 v[176:177], v24 offset:10240
    ds_read_b64_tr_b16 v[178:179], v24 offset:11264
    s_waitcnt lgkmcnt(2)
    v_mfma_f32_32x32x16_bf16 v[80:95], v[188:191], v[228:231], v[80:95]
    ds_read_b64_tr_b16 v[180:181], v25 offset:10240
    ds_read_b64_tr_b16 v[182:183], v25 offset:11264
    v_max3_u32 v28, v28, v228, v229
    v_max3_u32 v28, v28, v230, v231
    s_waitcnt vmcnt(5) lgkmcnt(2)
    v_mfma_f32_32x32x16_bf16 v[64:79], v[176:179], v[232:235], v[64:79]
    ds_read_b64_tr_b16 v[184:185], v26 offset:10240
    ds_read_b64_tr_b16 v[186:187], v26 offset:11264
    s_waitcnt lgkmcnt(2)
    v_mfma_f32_32x32x16_bf16 v[80:95], v[180:183], v[232:235], v[80:95]
    ds_read_b64_tr_b16 v[188:189], v27 offset:10240
    ds_read_b64_tr_b16 v[190:191], v27 offset:11264
    v_max3_u32 v28, v28, v232, v233
    v_max3_u32 v28, v28, v234, v235
    s_waitcnt vmcnt(4) lgkmcnt(2)
    v_mfma_f32_32x32x16_bf16 v[64:79], v[184:187], v[236:239], v[64:79]
    ds_read_b64_tr_b16 v[176:177], v26 offset:12288
    ds_read_b64_tr_b16 v[178:179], v26 offset:13312
    s_waitcnt lgkmcnt(2)
    v_mfma_f32_32x32x16_bf16 v[80:95], v[188:191], v[236:239], v[80:95]
    ds_read_b64_tr_b16 v[180:181], v27 offset:12288
    ds_read_b64_tr_b16 v[182:183], v27 offset:13312
    v_max3_u32 v28, v28, v236, v237
    v_max3_u32 v28, v28, v238, v239
    s_waitcnt vmcnt(3) lgkmcnt(2)
    v_mfma_f32_32x32x16_bf16 v[64:79], v[176:179], v[240:243], v[64:79]
    ds_read_b64_tr_b16 v[184:185], v26 offset:14336
    ds_read_b64_tr_b16 v[186:187], v26 offset:15360
    s_waitcnt lgkmcnt(2)
    v_mfma_f32_32x32x16_bf16 v[80:95], v[180:183], v[240:243], v[80:95]
    ds_read_b64_tr_b16 v[188:189], v27 offset:14336
    ds_read_b64_tr_b16 v[190:191], v27 offset:15360
    v_max3_u32 v28, v28, v240, v241
    v_max3_u32 v28, v28, v242, v243
    s_waitcnt vmcnt(2) lgkmcnt(2)
    v_mfma_f32_32x32x16_bf16 v[64:79], v[184:187], v[244:247], v[64:79]
    ds_read_b64_tr_b16 v[176:177], v26 offset:16384
    ds_read_b64_tr_b16 v[178:179], v26 offset:17408
    s_waitcnt lgkmcnt(2)
    v_mfma_f32_32x32x16_bf16 v[80:95], v[188:191], v[244:247], v[80:95]
    ds_read_b64_tr_b16 v[180:181], v27 offset:16384
    ds_read_b64_tr_b16 v[182:183], v27 offset:17408
    v_max3_u32 v28, v28, v244, v245
    v_max3_u32 v28, v28, v246, v247
    s_waitcnt vmcnt(1) lgkmcnt(2)
    v_mfma_f32_32x32x16_bf16 v[64:79], v[176:179], v[248:251], v[64:79]
    ds_read_b64_tr_b16 v[184:185], v26 offset:18432
    ds_read_b64_tr_b16 v[186:187], v26 offset:19456
    s_waitcnt lgkmcnt(2)
    v_mfma_f32_32x32x16_bf16 v[80:95], v[180:183], v[248:251], v[80:95]
    ds_read_b64_tr_b16 v[188:189], v27 offset:18432
    ds_read_b64_tr_b16 v[190:191], v27 offset:19456
    v_max3_u32 v28, v28, v248, v249
    v_max3_u32 v28, v28, v250, v251
    s_waitcnt vmcnt(0) lgkmcnt(0)
    v_mfma_f32_32x32x16_bf16 v[80:95], v[188:191], v[252:255], v[80:95]
    v_mfma_f32_32x32x16_bf16 v[64:79], v[184:187], v[252:255], v[64:79]
    v_max3_u32 v28, v28, v252, v253
    v_max3_u32 v28, v28, v254, v255
    v_cmp_ne_u32 vcc, -1, v28
    s_nop 1
    s_cmp_eq_u64 vcc, -1
    s_cbranch_scc0 L_retry
L_ok:
    s_nop 3
    ds_write_b128 v20, v[80:83] offset:0
    ds_write_b128 v20, v[84:87] offset:1024
    ds_write_b128 v20, v[88:91] offset:2048
    ds_write_b128 v20, v[92:95] offset:3072
    s_waitcnt lgkmcnt(0)
    s_barrier
    ds_read_b128 v[96:99], v23 offset:0
    ds_read_b128 v[100:103], v23 offset:1024
    ds_read_b128 v[104:107], v23 offset:2048
    ds_read_b128 v[108:111], v23 offset:3072
    s_waitcnt lgkmcnt(3)
    v_pk_add_f32 v[64:65], v[64:65], v[96:97]
    v_pk_add_f32 v[66:67], v[66:67], v[98:99]
    s_waitcnt lgkmcnt(2)
    v_pk_add_f32 v[68:69], v[68:69], v[100:101]
    v_pk_add_f32 v[70:71], v[70:71], v[102:103]
    v_cvt_pk_bf16_f32 v176, v64, v65
    v_cvt_pk_bf16_f32 v178, v68, v69
    v_cvt_pk_bf16_f32 v177, v66, v67
    v_cvt_pk_bf16_f32 v179, v70, v71
    v_permlane32_swap_b32 v176, v178
    s_nop 0
    v_permlane32_swap_b32 v177, v179
    buffer_store_dwordx4 v[176:179], v19, s[44:47], 0 offen
    s_waitcnt lgkmcnt(1)
    v_pk_add_f32 v[72:73], v[72:73], v[104:105]
    v_pk_add_f32 v[74:75], v[74:75], v[106:107]
    s_waitcnt lgkmcnt(0)
    v_pk_add_f32 v[76:77], v[76:77], v[108:109]
    v_pk_add_f32 v[78:79], v[78:79], v[110:111]
    v_cvt_pk_bf16_f32 v180, v72, v73
    v_cvt_pk_bf16_f32 v182, v76, v77
    v_cvt_pk_bf16_f32 v181, v74, v75
    v_cvt_pk_bf16_f32 v183, v78, v79
    v_permlane32_swap_b32 v180, v182
    s_nop 0
    v_permlane32_swap_b32 v181, v183
    buffer_store_dwordx4 v[180:183], v19, s[44:47], 0 offen offset:32
    s_endpgm
L_crole:
    s_lshr_b32 s60, s2, 3
    s_and_b32 s57, s2, 7
    s_lshl_b32 s57, s57, 2
    s_lshr_b32 s63, s60, 3
    s_add_u32 s57, s57, s63
    s_and_b32 s58, s60, 7
    s_lshl_b32 s56, s53, 2
    s_add_u32 s56, s56, s52
    s_mov_b32 s98, 0xffff
    s_mov_b32 s99, 0xffff
    v_lshlrev_b32 v2, 4, v1
    s_setprio 1
    v_and_b32 v128, 31, v1
    v_lshrrev_b32 v129, 5, v1
    v_lshrrev_b32 v140, 4, v1
    v_and_b32 v134, 15, v1
    v_lshrrev_b32 v133, 1, v134
    v_xor_b32 v133, v133, v140
    v_lshlrev_b32 v133, 4, v133
    v_lshl_add_u32 v133, v134, 7, v133
    v_add_u32 v192, 81920, v133
    v_xor_b32 v193, 64, v192
    v_bfe_u32 v130, v1, 2, 2
    v_and_b32 v131, 3, v1
    v_and_b32 v132, 1, v140
    v_lshl_add_u32 v133, v140, 3, v130
    v_xor_b32 v134, s52, v130
    v_lshlrev_b32 v134, 5, v134
    v_lshl_add_u32 v134, v131, 3, v134
    v_lshl_add_u32 v134, v133, 8, v134
    v_lshl_add_u32 v194, v132, 7, v134
    v_add_u32 v195, 0x10000, v194
    v_xor_b32 v196, 0x80, v194
    v_xor_b32 v197, 0x80, v195
    v_lshrrev_b32 v134, 1, v130
    v_lshl_add_u32 v134, v132, 1, v134
    v_xor_b32 v134, s52, v134
    v_lshlrev_b32 v134, 5, v134
    v_lshl_add_u32 v134, v131, 3, v134
    v_lshl_add_u32 v198, v133, 7, v134
    v_add_u32 v199, 0x10000, v198
    v_and_b32 v133, 15, v1
    v_lshlrev_b32 v133, 4, v133
    v_lshl_add_u32 v133, v129, 8, v133
    v_lshl_add_u32 v200, v132, 31, v133
    v_xor_b32 v201, 2147483648, v200
    v_lshlrev_b32 v133, 2, v129
    v_sub_u32 v135, v128, v133
    v_sub_u32 v133, 32, v135
    v_mov_b32 v134, 0xaaabfffe
    v_alignbit_b32 v202, v134, v134, v133
    s_waitcnt lgkmcnt(0)
    s_memrealtime s[100:101]
    s_mov_b32 s10, 0x3eb8aa3b
    s_mov_b32 s11, 0x3eb8aa3b
    s_mov_b32 s32, s22
    s_mov_b32 s33, s23
    s_mov_b32 s34, 16777216
    s_mov_b32 s35, 0x20000
    s_mov_b32 s48, s20
    s_mov_b32 s49, s21
    s_mov_b32 s50, 256
    s_mov_b32 s51, 0x20000
    s_cmp_eq_u32 s2, 0
    s_cselect_b32 s96, 0, 2147483648
    v_lshlrev_b32 v5, 8, v0
    v_or_b32 v5, s96, v5
    s_waitcnt lgkmcnt(0)
    v_mov_b32 v6, s100
    v_mov_b32 v7, s101
    buffer_store_dwordx2 v[6:7], v5, s[48:51], 0 offen sc1
    s_lshl_b32 s96, s52, 11
    v_add_u32 v4, s96, v192
    v_add_u32 v5, s96, v193
    v_lshlrev_b32 v8, 4, v140
    v_add_u32 v8, 156672, v8
    s_waitcnt vmcnt(1)
    v_lshlrev_b32 v13, 2, v128
    v_add_u32 v13, 157696, v13
    v_and_b32 v133, 15, v1
    s_lshl_b32 s96, s52, 6
    s_add_u32 s96, s96, 157696
    v_lshl_add_u32 v9, v133, 2, s96
    v_and_b32 v136, 31, v1
    v_lshrrev_b32 v137, 5, v1
    v_lshlrev_b32 v139, 2, v137
    v_sub_u32 v138, v136, v139
    s_mul_i32 s96, s52, 2080
    s_add_u32 s96, s96, 65536
    v_add_u32 v10, s96, v2
    v_and_b32 v139, 15, v1
    v_lshlrev_b32 v139, 4, v139
    v_lshl_add_u32 v139, v137, 8, v139
    v_and_b32 v137, 11, v1
    v_min_u32 v137, 1, v137
    v_lshlrev_b32 v137, 4, v137
    v_add_u32 v137, 0x400, v137
    v_cndmask_b32 v11, v137, v139, s[98:99]
    v_subrev_u32 v137, 0x200, v137
    v_cndmask_b32 v12, v137, v139, s[98:99]
    v_add_u32 v11, s96, v11
    v_add_u32 v12, s96, v12
    v_mov_b32 v139, 0xffff
    v_cmp_le_i32 s[64:65], 0, v138
    v_cmp_le_i32 s[66:67], 1, v138
    v_cmp_le_i32 s[68:69], 2, v138
    v_cmp_le_i32 s[70:71], 3, v138
    v_cmp_le_i32 s[72:73], 8, v138
    v_cmp_le_i32 s[74:75], 9, v138
    v_cmp_le_i32 s[76:77], 10, v138
    v_cmp_le_i32 s[78:79], 11, v138
    v_cmp_le_i32 s[80:81], 16, v138
    v_cmp_le_i32 s[82:83], 17, v138
    v_cmp_le_i32 s[84:85], 18, v138
    v_cmp_le_i32 s[86:87], 19, v138
    v_cmp_le_i32 s[88:89], 24, v138
    v_cmp_le_i32 s[90:91], 25, v138
    v_cmp_le_i32 s[92:93], 26, v138
    v_cmp_le_i32 s[94:95], 27, v138
    v_cndmask_b32 v16, 0, v139, s[64:65]
    v_cndmask_b32 v17, 0, v139, s[68:69]
    v_cndmask_b32 v18, 0, v139, s[72:73]
    v_cndmask_b32 v19, 0, v139, s[76:77]
    v_cndmask_b32 v20, 0, v139, s[80:81]
    v_cndmask_b32 v21, 0, v139, s[84:85]
    v_cndmask_b32 v22, 0, v139, s[88:89]
    v_cndmask_b32 v23, 0, v139, s[92:93]
    v_cndmask_b32 v16, v16, -1, s[66:67]
    v_cndmask_b32 v17, v17, -1, s[70:71]
    v_cndmask_b32 v18, v18, -1, s[74:75]
    v_cndmask_b32 v19, v19, -1, s[78:79]
    v_cndmask_b32 v20, v20, -1, s[82:83]
    v_cndmask_b32 v21, v21, -1, s[86:87]
    v_cndmask_b32 v22, v22, -1, s[90:91]
    v_cndmask_b32 v23, v23, -1, s[94:95]
    s_barrier
    ds_read_b64_tr_b16 v[160:161], v194 offset:0
    ds_read_b64_tr_b16 v[162:163], v194 offset:1024
    ds_read_b128 v[128:131], v192 offset:0
    ds_read_b128 v[132:135], v192 offset:2048
    ds_read_b64_tr_b16 v[164:165], v196 offset:8192
    ds_read_b64_tr_b16 v[166:167], v196 offset:9216
    ds_read_b128 v[136:139], v192 offset:4096
    ds_read_b128 v[140:143], v192 offset:6144
    ds_read_b64_tr_b16 v[168:169], v196 offset:0
    ds_read_b64_tr_b16 v[170:171], v196 offset:1024
    ds_read_b64_tr_b16 v[172:173], v194 offset:8192
    ds_read_b64_tr_b16 v[174:175], v194 offset:9216
    s_waitcnt lgkmcnt(9)
    v_mfma_f32_16x16x32_bf16 v[32:35], v[160:163], v[128:131], 0
    s_waitcnt lgkmcnt(8)
    v_mfma_f32_16x16x32_bf16 v[36:39], v[160:163], v[132:135], 0
    s_waitcnt lgkmcnt(0)
    s_barrier
    ds_read_b64_tr_b16 v[176:177], v194 offset:16384
    v_mfma_f32_16x16x32_bf16 v[48:51], v[164:167], v[128:131], 0
    ds_read_b64_tr_b16 v[178:179], v194 offset:17408
    v_mfma_f32_16x16x32_bf16 v[52:55], v[164:167], v[132:135], 0
    ds_read_b128 v[144:147], v193 offset:0
    ds_read_b128 v[148:151], v193 offset:2048
    v_mfma_f32_16x16x32_bf16 v[40:43], v[160:163], v[136:139], 0
    ds_read_b64_tr_b16 v[180:181], v196 offset:24576
    v_mfma_f32_16x16x32_bf16 v[44:47], v[160:163], v[140:143], 0
    ds_read_b64_tr_b16 v[182:183], v196 offset:25600
    ds_read_b128 v[152:155], v193 offset:4096
    v_mfma_f32_16x16x32_bf16 v[56:59], v[164:167], v[136:139], 0
    ds_read_b128 v[156:159], v193 offset:6144
    v_mfma_f32_16x16x32_bf16 v[60:63], v[164:167], v[140:143], 0
    ds_read_b64_tr_b16 v[184:185], v196 offset:16384
    v_mfma_f32_16x16x32_bf16 v[64:67], v[128:131], v[168:171], 0
    ds_read_b64_tr_b16 v[186:187], v196 offset:17408
    ds_read_b64_tr_b16 v[188:189], v194 offset:24576
    v_mfma_f32_16x16x32_bf16 v[68:71], v[132:135], v[168:171], 0
    ds_read_b64_tr_b16 v[190:191], v194 offset:25600
    v_mfma_f32_16x16x32_bf16 v[72:75], v[136:139], v[168:171], 0
    ds_read_b128 v[252:255], v8 offset:64
    ds_read_b128 v[244:247], v5 offset:0
    v_mfma_f32_16x16x32_bf16 v[76:79], v[140:143], v[168:171], 0
    v_mfma_f32_16x16x32_bf16 v[80:83], v[128:131], v[172:175], 0
    v_mfma_f32_16x16x32_bf16 v[84:87], v[132:135], v[172:175], 0
    v_mfma_f32_16x16x32_bf16 v[88:91], v[136:139], v[172:175], 0
    v_mfma_f32_16x16x32_bf16 v[92:95], v[140:143], v[172:175], 0
    s_waitcnt lgkmcnt(11)
    v_mfma_f32_16x16x32_bf16 v[32:35], v[176:179], v[144:147], v[32:35]
    s_waitcnt lgkmcnt(10)
    v_mfma_f32_16x16x32_bf16 v[36:39], v[176:179], v[148:151], v[36:39]
    s_waitcnt lgkmcnt(0)
    s_barrier
    ds_read_b64_tr_b16 v[160:161], v194 offset:32768
    v_mfma_f32_16x16x32_bf16 v[48:51], v[180:183], v[144:147], v[48:51]
    ds_read_b64_tr_b16 v[162:163], v194 offset:33792
    v_mfma_f32_16x16x32_bf16 v[52:55], v[180:183], v[148:151], v[52:55]
    ds_read_b128 v[128:131], v192 offset:8192
    v_mfma_f32_16x16x32_bf16 v[40:43], v[176:179], v[152:155], v[40:43]
    ds_read_b128 v[132:135], v192 offset:10240
    ds_read_b64_tr_b16 v[164:165], v196 offset:40960
    v_mfma_f32_16x16x32_bf16 v[44:47], v[176:179], v[156:159], v[44:47]
    ds_read_b64_tr_b16 v[166:167], v196 offset:41984
    v_mfma_f32_16x16x32_bf16 v[56:59], v[180:183], v[152:155], v[56:59]
    ds_read_b128 v[136:139], v192 offset:12288
    v_mfma_f32_16x16x32_bf16 v[60:63], v[180:183], v[156:159], v[60:63]
    ds_read_b128 v[140:143], v192 offset:14336
    v_mfma_f32_16x16x32_bf16 v[64:67], v[144:147], v[184:187], v[64:67]
    ds_read_b64_tr_b16 v[168:169], v196 offset:32768
    ds_read_b64_tr_b16 v[170:171], v196 offset:33792
    v_mfma_f32_16x16x32_bf16 v[68:71], v[148:151], v[184:187], v[68:71]
    ds_read_b64_tr_b16 v[172:173], v194 offset:40960
    v_mfma_f32_16x16x32_bf16 v[72:75], v[152:155], v[184:187], v[72:75]
    ds_read_b64_tr_b16 v[174:175], v194 offset:41984
    v_mfma_f32_16x16x32_bf16 v[76:79], v[156:159], v[184:187], v[76:79]
    ds_read_b128 v[248:251], v8 offset:128
    ds_read_b128 v[240:243], v4 offset:8192
    v_mfma_f32_16x16x32_bf16 v[80:83], v[144:147], v[188:191], v[80:83]
    v_mfma_f32_16x16x32_bf16 v[84:87], v[148:151], v[188:191], v[84:87]
    v_mfma_f32_16x16x32_bf16 v[88:91], v[152:155], v[188:191], v[88:91]
    v_mfma_f32_16x16x32_bf16 v[92:95], v[156:159], v[188:191], v[92:95]
    v_mfma_f32_16x16x32_bf16 v[204:207], v[252:255], v[244:247], 0
    s_waitcnt lgkmcnt(11)
    v_mfma_f32_16x16x32_bf16 v[32:35], v[160:163], v[128:131], v[32:35]
    s_waitcnt lgkmcnt(10)
    v_mfma_f32_16x16x32_bf16 v[36:39], v[160:163], v[132:135], v[36:39]
    s_waitcnt lgkmcnt(0)
    s_barrier
    ds_read_b64_tr_b16 v[176:177], v194 offset:49152
    v_mfma_f32_16x16x32_bf16 v[48:51], v[164:167], v[128:131], v[48:51]
    ds_read_b64_tr_b16 v[178:179], v194 offset:50176
    v_mfma_f32_16x16x32_bf16 v[52:55], v[164:167], v[132:135], v[52:55]
    ds_read_b128 v[144:147], v193 offset:8192
    v_mfma_f32_16x16x32_bf16 v[40:43], v[160:163], v[136:139], v[40:43]
    ds_read_b128 v[148:151], v193 offset:10240
    ds_read_b64_tr_b16 v[180:181], v196 offset:57344
    v_mfma_f32_16x16x32_bf16 v[44:47], v[160:163], v[140:143], v[44:47]
    ds_read_b64_tr_b16 v[182:183], v196 offset:58368
    v_mfma_f32_16x16x32_bf16 v[56:59], v[164:167], v[136:139], v[56:59]
    ds_read_b128 v[152:155], v193 offset:12288
    v_mfma_f32_16x16x32_bf16 v[60:63], v[164:167], v[140:143], v[60:63]
    ds_read_b128 v[156:159], v193 offset:14336
    v_mfma_f32_16x16x32_bf16 v[64:67], v[128:131], v[168:171], v[64:67]
    ds_read_b64_tr_b16 v[184:185], v196 offset:49152
    ds_read_b64_tr_b16 v[186:187], v196 offset:50176
    v_mfma_f32_16x16x32_bf16 v[68:71], v[132:135], v[168:171], v[68:71]
    ds_read_b64_tr_b16 v[188:189], v194 offset:57344
    v_mfma_f32_16x16x32_bf16 v[72:75], v[136:139], v[168:171], v[72:75]
    ds_read_b64_tr_b16 v[190:191], v194 offset:58368
    v_mfma_f32_16x16x32_bf16 v[76:79], v[140:143], v[168:171], v[76:79]
    ds_read_b128 v[252:255], v8 offset:192
    ds_read_b128 v[244:247], v5 offset:8192
    v_mfma_f32_16x16x32_bf16 v[80:83], v[128:131], v[172:175], v[80:83]
    v_mfma_f32_16x16x32_bf16 v[84:87], v[132:135], v[172:175], v[84:87]
    v_mfma_f32_16x16x32_bf16 v[88:91], v[136:139], v[172:175], v[88:91]
    v_mfma_f32_16x16x32_bf16 v[92:95], v[140:143], v[172:175], v[92:95]
    v_mfma_f32_16x16x32_bf16 v[204:207], v[248:251], v[240:243], v[204:207]
    s_waitcnt lgkmcnt(11)
    v_mfma_f32_16x16x32_bf16 v[32:35], v[176:179], v[144:147], v[32:35]
    s_waitcnt lgkmcnt(10)
    v_mfma_f32_16x16x32_bf16 v[36:39], v[176:179], v[148:151], v[36:39]
    s_waitcnt lgkmcnt(0)
    s_barrier
    ds_read_b64_tr_b16 v[160:161], v195 offset:0
    v_mfma_f32_16x16x32_bf16 v[48:51], v[180:183], v[144:147], v[48:51]
    ds_read_b64_tr_b16 v[162:163], v195 offset:1024
    v_mfma_f32_16x16x32_bf16 v[52:55], v[180:183], v[148:151], v[52:55]
    ds_read_b128 v[128:131], v192 offset:16384
    v_mfma_f32_16x16x32_bf16 v[40:43], v[176:179], v[152:155], v[40:43]
    ds_read_b128 v[132:135], v192 offset:18432
    ds_read_b64_tr_b16 v[164:165], v197 offset:8192
    v_mfma_f32_16x16x32_bf16 v[44:47], v[176:179], v[156:159], v[44:47]
    ds_read_b64_tr_b16 v[166:167], v197 offset:9216
    v_mfma_f32_16x16x32_bf16 v[56:59], v[180:183], v[152:155], v[56:59]
    ds_read_b128 v[136:139], v192 offset:20480
    v_mfma_f32_16x16x32_bf16 v[60:63], v[180:183], v[156:159], v[60:63]
    ds_read_b128 v[140:143], v192 offset:22528
    v_mfma_f32_16x16x32_bf16 v[64:67], v[144:147], v[184:187], v[64:67]
    ds_read_b64_tr_b16 v[168:169], v197 offset:0
    ds_read_b64_tr_b16 v[170:171], v197 offset:1024
    v_mfma_f32_16x16x32_bf16 v[68:71], v[148:151], v[184:187], v[68:71]
    ds_read_b64_tr_b16 v[172:173], v195 offset:8192
    v_mfma_f32_16x16x32_bf16 v[72:75], v[152:155], v[184:187], v[72:75]
    ds_read_b64_tr_b16 v[174:175], v195 offset:9216
    v_mfma_f32_16x16x32_bf16 v[76:79], v[156:159], v[184:187], v[76:79]
    ds_read_b128 v[248:251], v8 offset:256
    ds_read_b128 v[240:243], v4 offset:16384
    v_mfma_f32_16x16x32_bf16 v[80:83], v[144:147], v[188:191], v[80:83]
    v_mfma_f32_16x16x32_bf16 v[84:87], v[148:151], v[188:191], v[84:87]
    v_mfma_f32_16x16x32_bf16 v[88:91], v[152:155], v[188:191], v[88:91]
    v_mfma_f32_16x16x32_bf16 v[92:95], v[156:159], v[188:191], v[92:95]
    v_mfma_f32_16x16x32_bf16 v[204:207], v[252:255], v[244:247], v[204:207]
    s_waitcnt lgkmcnt(11)
    v_mfma_f32_16x16x32_bf16 v[32:35], v[160:163], v[128:131], v[32:35]
    s_waitcnt lgkmcnt(10)
    v_mfma_f32_16x16x32_bf16 v[36:39], v[160:163], v[132:135], v[36:39]
    s_waitcnt lgkmcnt(0)
    s_barrier
    ds_read_b64_tr_b16 v[176:177], v194 offset:0
    v_mfma_f32_16x16x32_bf16 v[48:51], v[164:167], v[128:131], v[48:51]
    ds_read_b64_tr_b16 v[178:179], v194 offset:1024
    v_mfma_f32_16x16x32_bf16 v[52:55], v[164:167], v[132:135], v[52:55]
    ds_read_b128 v[144:147], v193 offset:16384
    v_mfma_f32_16x16x32_bf16 v[40:43], v[160:163], v[136:139], v[40:43]
    ds_read_b128 v[148:151], v193 offset:18432
    ds_read_b64_tr_b16 v[180:181], v196 offset:8192
    v_mfma_f32_16x16x32_bf16 v[44:47], v[160:163], v[140:143], v[44:47]
    ds_read_b64_tr_b16 v[182:183], v196 offset:9216
    v_mfma_f32_16x16x32_bf16 v[56:59], v[164:167], v[136:139], v[56:59]
    ds_read_b128 v[152:155], v193 offset:20480
    v_mfma_f32_16x16x32_bf16 v[60:63], v[164:167], v[140:143], v[60:63]
    ds_read_b128 v[156:159], v193 offset:22528
    v_mfma_f32_16x16x32_bf16 v[64:67], v[128:131], v[168:171], v[64:67]
    ds_read_b64_tr_b16 v[184:185], v196 offset:0
    ds_read_b64_tr_b16 v[186:187], v196 offset:1024
    v_mfma_f32_16x16x32_bf16 v[68:71], v[132:135], v[168:171], v[68:71]
    ds_read_b64_tr_b16 v[188:189], v194 offset:8192
    v_mfma_f32_16x16x32_bf16 v[72:75], v[136:139], v[168:171], v[72:75]
    ds_read_b64_tr_b16 v[190:191], v194 offset:9216
    v_mfma_f32_16x16x32_bf16 v[76:79], v[140:143], v[168:171], v[76:79]
    ds_read_b128 v[252:255], v8 offset:320
    ds_read_b128 v[244:247], v5 offset:16384
    v_mfma_f32_16x16x32_bf16 v[80:83], v[128:131], v[172:175], v[80:83]
    v_mfma_f32_16x16x32_bf16 v[84:87], v[132:135], v[172:175], v[84:87]
    v_mfma_f32_16x16x32_bf16 v[88:91], v[136:139], v[172:175], v[88:91]
    v_mfma_f32_16x16x32_bf16 v[92:95], v[140:143], v[172:175], v[92:95]
    v_mfma_f32_16x16x32_bf16 v[204:207], v[248:251], v[240:243], v[204:207]
    s_waitcnt lgkmcnt(11)
    v_mfma_f32_16x16x32_bf16 v[32:35], v[176:179], v[144:147], v[32:35]
    s_waitcnt lgkmcnt(10)
    v_mfma_f32_16x16x32_bf16 v[36:39], v[176:179], v[148:151], v[36:39]
    s_waitcnt lgkmcnt(0)
    s_barrier
    ds_read_b64_tr_b16 v[160:161], v194 offset:16384
    v_mfma_f32_16x16x32_bf16 v[48:51], v[180:183], v[144:147], v[48:51]
    ds_read_b64_tr_b16 v[162:163], v194 offset:17408
    v_mfma_f32_16x16x32_bf16 v[52:55], v[180:183], v[148:151], v[52:55]
    ds_read_b128 v[128:131], v192 offset:24576
    v_mfma_f32_16x16x32_bf16 v[40:43], v[176:179], v[152:155], v[40:43]
    ds_read_b128 v[132:135], v192 offset:26624
    ds_read_b64_tr_b16 v[164:165], v196 offset:24576
    v_mfma_f32_16x16x32_bf16 v[44:47], v[176:179], v[156:159], v[44:47]
    ds_read_b64_tr_b16 v[166:167], v196 offset:25600
    v_mfma_f32_16x16x32_bf16 v[56:59], v[180:183], v[152:155], v[56:59]
    ds_read_b128 v[136:139], v192 offset:28672
    v_mfma_f32_16x16x32_bf16 v[60:63], v[180:183], v[156:159], v[60:63]
    ds_read_b128 v[140:143], v192 offset:30720
    v_mfma_f32_16x16x32_bf16 v[64:67], v[144:147], v[184:187], v[64:67]
    ds_read_b64_tr_b16 v[168:169], v196 offset:16384
    ds_read_b64_tr_b16 v[170:171], v196 offset:17408
    v_mfma_f32_16x16x32_bf16 v[68:71], v[148:151], v[184:187], v[68:71]
    ds_read_b64_tr_b16 v[172:173], v194 offset:24576
    v_mfma_f32_16x16x32_bf16 v[72:75], v[152:155], v[184:187], v[72:75]
    ds_read_b64_tr_b16 v[174:175], v194 offset:25600
    v_mfma_f32_16x16x32_bf16 v[76:79], v[156:159], v[184:187], v[76:79]
    ds_read_b128 v[248:251], v8 offset:384
    ds_read_b128 v[240:243], v4 offset:24576
    v_mfma_f32_16x16x32_bf16 v[80:83], v[144:147], v[188:191], v[80:83]
    v_mfma_f32_16x16x32_bf16 v[84:87], v[148:151], v[188:191], v[84:87]
    v_mfma_f32_16x16x32_bf16 v[88:91], v[152:155], v[188:191], v[88:91]
    v_mfma_f32_16x16x32_bf16 v[92:95], v[156:159], v[188:191], v[92:95]
    v_mfma_f32_16x16x32_bf16 v[204:207], v[252:255], v[244:247], v[204:207]
    s_waitcnt lgkmcnt(11)
    v_mfma_f32_16x16x32_bf16 v[32:35], v[160:163], v[128:131], v[32:35]
    s_waitcnt lgkmcnt(10)
    v_mfma_f32_16x16x32_bf16 v[36:39], v[160:163], v[132:135], v[36:39]
    s_waitcnt lgkmcnt(0)
    s_barrier
    ds_read_b64_tr_b16 v[176:177], v194 offset:32768
    v_mfma_f32_16x16x32_bf16 v[48:51], v[164:167], v[128:131], v[48:51]
    ds_read_b64_tr_b16 v[178:179], v194 offset:33792
    v_mfma_f32_16x16x32_bf16 v[52:55], v[164:167], v[132:135], v[52:55]
    ds_read_b128 v[144:147], v193 offset:24576
    v_mfma_f32_16x16x32_bf16 v[40:43], v[160:163], v[136:139], v[40:43]
    ds_read_b128 v[148:151], v193 offset:26624
    ds_read_b64_tr_b16 v[180:181], v196 offset:40960
    v_mfma_f32_16x16x32_bf16 v[44:47], v[160:163], v[140:143], v[44:47]
    ds_read_b64_tr_b16 v[182:183], v196 offset:41984
    v_mfma_f32_16x16x32_bf16 v[56:59], v[164:167], v[136:139], v[56:59]
    ds_read_b128 v[152:155], v193 offset:28672
    v_mfma_f32_16x16x32_bf16 v[60:63], v[164:167], v[140:143], v[60:63]
    ds_read_b128 v[156:159], v193 offset:30720
    v_mfma_f32_16x16x32_bf16 v[64:67], v[128:131], v[168:171], v[64:67]
    ds_read_b64_tr_b16 v[184:185], v196 offset:32768
    ds_read_b64_tr_b16 v[186:187], v196 offset:33792
    v_mfma_f32_16x16x32_bf16 v[68:71], v[132:135], v[168:171], v[68:71]
    ds_read_b64_tr_b16 v[188:189], v194 offset:40960
    v_mfma_f32_16x16x32_bf16 v[72:75], v[136:139], v[168:171], v[72:75]
    ds_read_b64_tr_b16 v[190:191], v194 offset:41984
    v_mfma_f32_16x16x32_bf16 v[76:79], v[140:143], v[168:171], v[76:79]
    ds_read_b128 v[252:255], v8 offset:448
    ds_read_b128 v[244:247], v5 offset:24576
    v_mfma_f32_16x16x32_bf16 v[80:83], v[128:131], v[172:175], v[80:83]
    v_mfma_f32_16x16x32_bf16 v[84:87], v[132:135], v[172:175], v[84:87]
    v_mfma_f32_16x16x32_bf16 v[88:91], v[136:139], v[172:175], v[88:91]
    v_mfma_f32_16x16x32_bf16 v[92:95], v[140:143], v[172:175], v[92:95]
    v_mfma_f32_16x16x32_bf16 v[204:207], v[248:251], v[240:243], v[204:207]
    s_waitcnt lgkmcnt(11)
    v_mfma_f32_16x16x32_bf16 v[32:35], v[176:179], v[144:147], v[32:35]
    s_waitcnt lgkmcnt(10)
    v_mfma_f32_16x16x32_bf16 v[36:39], v[176:179], v[148:151], v[36:39]
    s_waitcnt lgkmcnt(0)
    s_barrier
    ds_read_b64_tr_b16 v[160:161], v194 offset:49152
    v_mfma_f32_16x16x32_bf16 v[48:51], v[180:183], v[144:147], v[48:51]
    ds_read_b64_tr_b16 v[162:163], v194 offset:50176
    v_mfma_f32_16x16x32_bf16 v[52:55], v[180:183], v[148:151], v[52:55]
    ds_read_b128 v[128:131], v192 offset:32768
    v_mfma_f32_16x16x32_bf16 v[40:43], v[176:179], v[152:155], v[40:43]
    ds_read_b128 v[132:135], v192 offset:34816
    ds_read_b64_tr_b16 v[164:165], v196 offset:57344
    v_mfma_f32_16x16x32_bf16 v[44:47], v[176:179], v[156:159], v[44:47]
    ds_read_b64_tr_b16 v[166:167], v196 offset:58368
    v_mfma_f32_16x16x32_bf16 v[56:59], v[180:183], v[152:155], v[56:59]
    ds_read_b128 v[136:139], v192 offset:36864
    v_mfma_f32_16x16x32_bf16 v[60:63], v[180:183], v[156:159], v[60:63]
    ds_read_b128 v[140:143], v192 offset:38912
    v_mfma_f32_16x16x32_bf16 v[64:67], v[144:147], v[184:187], v[64:67]
    ds_read_b64_tr_b16 v[168:169], v196 offset:49152
    ds_read_b64_tr_b16 v[170:171], v196 offset:50176
    v_mfma_f32_16x16x32_bf16 v[68:71], v[148:151], v[184:187], v[68:71]
    ds_read_b64_tr_b16 v[172:173], v194 offset:57344
    v_mfma_f32_16x16x32_bf16 v[72:75], v[152:155], v[184:187], v[72:75]
    ds_read_b64_tr_b16 v[174:175], v194 offset:58368
    v_mfma_f32_16x16x32_bf16 v[76:79], v[156:159], v[184:187], v[76:79]
    ds_read_b128 v[248:251], v8 offset:512
    ds_read_b128 v[240:243], v4 offset:32768
    v_mfma_f32_16x16x32_bf16 v[80:83], v[144:147], v[188:191], v[80:83]
    v_mfma_f32_16x16x32_bf16 v[84:87], v[148:151], v[188:191], v[84:87]
    v_mfma_f32_16x16x32_bf16 v[88:91], v[152:155], v[188:191], v[88:91]
    v_mfma_f32_16x16x32_bf16 v[92:95], v[156:159], v[188:191], v[92:95]
    v_mfma_f32_16x16x32_bf16 v[204:207], v[252:255], v[244:247], v[204:207]
    s_waitcnt lgkmcnt(11)
    v_mfma_f32_16x16x32_bf16 v[32:35], v[160:163], v[128:131], v[32:35]
    s_waitcnt lgkmcnt(10)
    v_mfma_f32_16x16x32_bf16 v[36:39], v[160:163], v[132:135], v[36:39]
    s_waitcnt lgkmcnt(0)
    s_barrier
    ds_read_b64_tr_b16 v[176:177], v195 offset:0
    v_mfma_f32_16x16x32_bf16 v[48:51], v[164:167], v[128:131], v[48:51]
    ds_read_b64_tr_b16 v[178:179], v195 offset:1024
    v_mfma_f32_16x16x32_bf16 v[52:55], v[164:167], v[132:135], v[52:55]
    ds_read_b128 v[144:147], v193 offset:32768
    v_mfma_f32_16x16x32_bf16 v[40:43], v[160:163], v[136:139], v[40:43]
    ds_read_b128 v[148:151], v193 offset:34816
    ds_read_b64_tr_b16 v[180:181], v197 offset:8192
    v_mfma_f32_16x16x32_bf16 v[44:47], v[160:163], v[140:143], v[44:47]
    ds_read_b64_tr_b16 v[182:183], v197 offset:9216
    v_mfma_f32_16x16x32_bf16 v[56:59], v[164:167], v[136:139], v[56:59]
    ds_read_b128 v[152:155], v193 offset:36864
    v_mfma_f32_16x16x32_bf16 v[60:63], v[164:167], v[140:143], v[60:63]
    ds_read_b128 v[156:159], v193 offset:38912
    v_mfma_f32_16x16x32_bf16 v[64:67], v[128:131], v[168:171], v[64:67]
    ds_read_b64_tr_b16 v[184:185], v197 offset:0
    ds_read_b64_tr_b16 v[186:187], v197 offset:1024
    v_mfma_f32_16x16x32_bf16 v[68:71], v[132:135], v[168:171], v[68:71]
    ds_read_b64_tr_b16 v[188:189], v195 offset:8192
    v_mfma_f32_16x16x32_bf16 v[72:75], v[136:139], v[168:171], v[72:75]
    ds_read_b64_tr_b16 v[190:191], v195 offset:9216
    v_mfma_f32_16x16x32_bf16 v[76:79], v[140:143], v[168:171], v[76:79]
    ds_read_b128 v[252:255], v8 offset:576
    ds_read_b128 v[244:247], v5 offset:32768
    v_mfma_f32_16x16x32_bf16 v[80:83], v[128:131], v[172:175], v[80:83]
    v_mfma_f32_16x16x32_bf16 v[84:87], v[132:135], v[172:175], v[84:87]
    v_mfma_f32_16x16x32_bf16 v[88:91], v[136:139], v[172:175], v[88:91]
    v_mfma_f32_16x16x32_bf16 v[92:95], v[140:143], v[172:175], v[92:95]
    v_mfma_f32_16x16x32_bf16 v[204:207], v[248:251], v[240:243], v[204:207]
    s_waitcnt lgkmcnt(11)
    v_mfma_f32_16x16x32_bf16 v[32:35], v[176:179], v[144:147], v[32:35]
    s_waitcnt lgkmcnt(10)
    v_mfma_f32_16x16x32_bf16 v[36:39], v[176:179], v[148:151], v[36:39]
    s_waitcnt lgkmcnt(0)
    s_barrier
    ds_read_b64_tr_b16 v[160:161], v194 offset:0
    v_mfma_f32_16x16x32_bf16 v[48:51], v[180:183], v[144:147], v[48:51]
    ds_read_b64_tr_b16 v[162:163], v194 offset:1024
    v_mfma_f32_16x16x32_bf16 v[52:55], v[180:183], v[148:151], v[52:55]
    ds_read_b128 v[128:131], v192 offset:40960
    v_mfma_f32_16x16x32_bf16 v[40:43], v[176:179], v[152:155], v[40:43]
    ds_read_b128 v[132:135], v192 offset:43008
    ds_read_b64_tr_b16 v[164:165], v196 offset:8192
    v_mfma_f32_16x16x32_bf16 v[44:47], v[176:179], v[156:159], v[44:47]
    ds_read_b64_tr_b16 v[166:167], v196 offset:9216
    v_mfma_f32_16x16x32_bf16 v[56:59], v[180:183], v[152:155], v[56:59]
    ds_read_b128 v[136:139], v192 offset:45056
    v_mfma_f32_16x16x32_bf16 v[60:63], v[180:183], v[156:159], v[60:63]
    ds_read_b128 v[140:143], v192 offset:47104
    v_mfma_f32_16x16x32_bf16 v[64:67], v[144:147], v[184:187], v[64:67]
    ds_read_b64_tr_b16 v[168:169], v196 offset:0
    ds_read_b64_tr_b16 v[170:171], v196 offset:1024
    v_mfma_f32_16x16x32_bf16 v[68:71], v[148:151], v[184:187], v[68:71]
    ds_read_b64_tr_b16 v[172:173], v194 offset:8192
    v_mfma_f32_16x16x32_bf16 v[72:75], v[152:155], v[184:187], v[72:75]
    ds_read_b64_tr_b16 v[174:175], v194 offset:9216
    v_mfma_f32_16x16x32_bf16 v[76:79], v[156:159], v[184:187], v[76:79]
    ds_read_b128 v[248:251], v8 offset:640
    ds_read_b128 v[240:243], v4 offset:40960
    v_mfma_f32_16x16x32_bf16 v[80:83], v[144:147], v[188:191], v[80:83]
    v_mfma_f32_16x16x32_bf16 v[84:87], v[148:151], v[188:191], v[84:87]
    v_mfma_f32_16x16x32_bf16 v[88:91], v[152:155], v[188:191], v[88:91]
    v_mfma_f32_16x16x32_bf16 v[92:95], v[156:159], v[188:191], v[92:95]
    v_mfma_f32_16x16x32_bf16 v[204:207], v[252:255], v[244:247], v[204:207]
    s_waitcnt lgkmcnt(11)
    v_mfma_f32_16x16x32_bf16 v[32:35], v[160:163], v[128:131], v[32:35]
    s_waitcnt lgkmcnt(10)
    v_mfma_f32_16x16x32_bf16 v[36:39], v[160:163], v[132:135], v[36:39]
    s_waitcnt lgkmcnt(0)
    s_barrier
    ds_read_b64_tr_b16 v[176:177], v194 offset:16384
    v_mfma_f32_16x16x32_bf16 v[48:51], v[164:167], v[128:131], v[48:51]
    ds_read_b64_tr_b16 v[178:179], v194 offset:17408
    v_mfma_f32_16x16x32_bf16 v[52:55], v[164:167], v[132:135], v[52:55]
    ds_read_b128 v[144:147], v193 offset:40960
    v_mfma_f32_16x16x32_bf16 v[40:43], v[160:163], v[136:139], v[40:43]
    ds_read_b128 v[148:151], v193 offset:43008
    ds_read_b64_tr_b16 v[180:181], v196 offset:24576
    v_mfma_f32_16x16x32_bf16 v[44:47], v[160:163], v[140:143], v[44:47]
    ds_read_b64_tr_b16 v[182:183], v196 offset:25600
    v_mfma_f32_16x16x32_bf16 v[56:59], v[164:167], v[136:139], v[56:59]
    ds_read_b128 v[152:155], v193 offset:45056
    v_mfma_f32_16x16x32_bf16 v[60:63], v[164:167], v[140:143], v[60:63]
    ds_read_b128 v[156:159], v193 offset:47104
    v_mfma_f32_16x16x32_bf16 v[64:67], v[128:131], v[168:171], v[64:67]
    ds_read_b64_tr_b16 v[184:185], v196 offset:16384
    ds_read_b64_tr_b16 v[186:187], v196 offset:17408
    v_mfma_f32_16x16x32_bf16 v[68:71], v[132:135], v[168:171], v[68:71]
    ds_read_b64_tr_b16 v[188:189], v194 offset:24576
    v_mfma_f32_16x16x32_bf16 v[72:75], v[136:139], v[168:171], v[72:75]
    ds_read_b64_tr_b16 v[190:191], v194 offset:25600
    v_mfma_f32_16x16x32_bf16 v[76:79], v[140:143], v[168:171], v[76:79]
    ds_read_b128 v[252:255], v8 offset:704
    ds_read_b128 v[244:247], v5 offset:40960
    v_mfma_f32_16x16x32_bf16 v[80:83], v[128:131], v[172:175], v[80:83]
    v_mfma_f32_16x16x32_bf16 v[84:87], v[132:135], v[172:175], v[84:87]
    v_mfma_f32_16x16x32_bf16 v[88:91], v[136:139], v[172:175], v[88:91]
    v_mfma_f32_16x16x32_bf16 v[92:95], v[140:143], v[172:175], v[92:95]
    v_mfma_f32_16x16x32_bf16 v[204:207], v[248:251], v[240:243], v[204:207]
    s_waitcnt lgkmcnt(11)
    v_mfma_f32_16x16x32_bf16 v[32:35], v[176:179], v[144:147], v[32:35]
    s_waitcnt lgkmcnt(10)
    v_mfma_f32_16x16x32_bf16 v[36:39], v[176:179], v[148:151], v[36:39]
    s_waitcnt lgkmcnt(0)
    s_barrier
    ds_read_b64_tr_b16 v[160:161], v194 offset:32768
    v_mfma_f32_16x16x32_bf16 v[48:51], v[180:183], v[144:147], v[48:51]
    ds_read_b64_tr_b16 v[162:163], v194 offset:33792
    v_mfma_f32_16x16x32_bf16 v[52:55], v[180:183], v[148:151], v[52:55]
    ds_read_b128 v[128:131], v192 offset:49152
    v_mfma_f32_16x16x32_bf16 v[40:43], v[176:179], v[152:155], v[40:43]
    ds_read_b128 v[132:135], v192 offset:51200
    ds_read_b64_tr_b16 v[164:165], v196 offset:40960
    v_mfma_f32_16x16x32_bf16 v[44:47], v[176:179], v[156:159], v[44:47]
    ds_read_b64_tr_b16 v[166:167], v196 offset:41984
    v_mfma_f32_16x16x32_bf16 v[56:59], v[180:183], v[152:155], v[56:59]
    ds_read_b128 v[136:139], v192 offset:53248
    v_mfma_f32_16x16x32_bf16 v[60:63], v[180:183], v[156:159], v[60:63]
    ds_read_b128 v[140:143], v192 offset:55296
    v_mfma_f32_16x16x32_bf16 v[64:67], v[144:147], v[184:187], v[64:67]
    ds_read_b64_tr_b16 v[168:169], v196 offset:32768
    ds_read_b64_tr_b16 v[170:171], v196 offset:33792
    v_mfma_f32_16x16x32_bf16 v[68:71], v[148:151], v[184:187], v[68:71]
    ds_read_b64_tr_b16 v[172:173], v194 offset:40960
    v_mfma_f32_16x16x32_bf16 v[72:75], v[152:155], v[184:187], v[72:75]
    ds_read_b64_tr_b16 v[174:175], v194 offset:41984
    v_mfma_f32_16x16x32_bf16 v[76:79], v[156:159], v[184:187], v[76:79]
    ds_read_b128 v[248:251], v8 offset:768
    ds_read_b128 v[240:243], v4 offset:49152
    v_mfma_f32_16x16x32_bf16 v[80:83], v[144:147], v[188:191], v[80:83]
    v_mfma_f32_16x16x32_bf16 v[84:87], v[148:151], v[188:191], v[84:87]
    v_mfma_f32_16x16x32_bf16 v[88:91], v[152:155], v[188:191], v[88:91]
    v_mfma_f32_16x16x32_bf16 v[92:95], v[156:159], v[188:191], v[92:95]
    v_mfma_f32_16x16x32_bf16 v[204:207], v[252:255], v[244:247], v[204:207]
    s_waitcnt lgkmcnt(11)
    v_mfma_f32_16x16x32_bf16 v[32:35], v[160:163], v[128:131], v[32:35]
    s_waitcnt lgkmcnt(10)
    v_mfma_f32_16x16x32_bf16 v[36:39], v[160:163], v[132:135], v[36:39]
    s_waitcnt lgkmcnt(0)
    s_barrier
    ds_read_b64_tr_b16 v[176:177], v194 offset:49152
    v_mfma_f32_16x16x32_bf16 v[48:51], v[164:167], v[128:131], v[48:51]
    ds_read_b64_tr_b16 v[178:179], v194 offset:50176
    v_mfma_f32_16x16x32_bf16 v[52:55], v[164:167], v[132:135], v[52:55]
    ds_read_b128 v[144:147], v193 offset:49152
    v_mfma_f32_16x16x32_bf16 v[40:43], v[160:163], v[136:139], v[40:43]
    ds_read_b128 v[148:151], v193 offset:51200
    ds_read_b64_tr_b16 v[180:181], v196 offset:57344
    v_mfma_f32_16x16x32_bf16 v[44:47], v[160:163], v[140:143], v[44:47]
    ds_read_b64_tr_b16 v[182:183], v196 offset:58368
    v_mfma_f32_16x16x32_bf16 v[56:59], v[164:167], v[136:139], v[56:59]
    ds_read_b128 v[152:155], v193 offset:53248
    v_mfma_f32_16x16x32_bf16 v[60:63], v[164:167], v[140:143], v[60:63]
    ds_read_b128 v[156:159], v193 offset:55296
    v_mfma_f32_16x16x32_bf16 v[64:67], v[128:131], v[168:171], v[64:67]
    ds_read_b64_tr_b16 v[184:185], v196 offset:49152
    ds_read_b64_tr_b16 v[186:187], v196 offset:50176
    v_mfma_f32_16x16x32_bf16 v[68:71], v[132:135], v[168:171], v[68:71]
    ds_read_b64_tr_b16 v[188:189], v194 offset:57344
    v_mfma_f32_16x16x32_bf16 v[72:75], v[136:139], v[168:171], v[72:75]
    ds_read_b64_tr_b16 v[190:191], v194 offset:58368
    v_mfma_f32_16x16x32_bf16 v[76:79], v[140:143], v[168:171], v[76:79]
    ds_read_b128 v[252:255], v8 offset:832
    ds_read_b128 v[244:247], v5 offset:49152
    v_mfma_f32_16x16x32_bf16 v[80:83], v[128:131], v[172:175], v[80:83]
    v_mfma_f32_16x16x32_bf16 v[84:87], v[132:135], v[172:175], v[84:87]
    v_mfma_f32_16x16x32_bf16 v[88:91], v[136:139], v[172:175], v[88:91]
    v_mfma_f32_16x16x32_bf16 v[92:95], v[140:143], v[172:175], v[92:95]
    v_mfma_f32_16x16x32_bf16 v[204:207], v[248:251], v[240:243], v[204:207]
    s_waitcnt lgkmcnt(11)
    v_mfma_f32_16x16x32_bf16 v[32:35], v[176:179], v[144:147], v[32:35]
    s_waitcnt lgkmcnt(10)
    v_mfma_f32_16x16x32_bf16 v[36:39], v[176:179], v[148:151], v[36:39]
    s_waitcnt lgkmcnt(0)
    s_barrier
    ds_read_b64_tr_b16 v[160:161], v195 offset:0
    v_mfma_f32_16x16x32_bf16 v[48:51], v[180:183], v[144:147], v[48:51]
    ds_read_b64_tr_b16 v[162:163], v195 offset:1024
    v_mfma_f32_16x16x32_bf16 v[52:55], v[180:183], v[148:151], v[52:55]
    ds_read_b128 v[128:131], v192 offset:57344
    v_mfma_f32_16x16x32_bf16 v[40:43], v[176:179], v[152:155], v[40:43]
    ds_read_b128 v[132:135], v192 offset:59392
    ds_read_b64_tr_b16 v[164:165], v197 offset:8192
    v_mfma_f32_16x16x32_bf16 v[44:47], v[176:179], v[156:159], v[44:47]
    ds_read_b64_tr_b16 v[166:167], v197 offset:9216
    v_mfma_f32_16x16x32_bf16 v[56:59], v[180:183], v[152:155], v[56:59]
    ds_read_b128 v[136:139], v192 offset:61440
    v_mfma_f32_16x16x32_bf16 v[60:63], v[180:183], v[156:159], v[60:63]
    ds_read_b128 v[140:143], v192 offset:63488
    v_mfma_f32_16x16x32_bf16 v[64:67], v[144:147], v[184:187], v[64:67]
    ds_read_b64_tr_b16 v[168:169], v197 offset:0
    ds_read_b64_tr_b16 v[170:171], v197 offset:1024
    v_mfma_f32_16x16x32_bf16 v[68:71], v[148:151], v[184:187], v[68:71]
    ds_read_b64_tr_b16 v[172:173], v195 offset:8192
    v_mfma_f32_16x16x32_bf16 v[72:75], v[152:155], v[184:187], v[72:75]
    ds_read_b64_tr_b16 v[174:175], v195 offset:9216
    v_mfma_f32_16x16x32_bf16 v[76:79], v[156:159], v[184:187], v[76:79]
    ds_read_b128 v[248:251], v8 offset:896
    ds_read_b128 v[240:243], v4 offset:57344
    v_mfma_f32_16x16x32_bf16 v[80:83], v[144:147], v[188:191], v[80:83]
    v_mfma_f32_16x16x32_bf16 v[84:87], v[148:151], v[188:191], v[84:87]
    v_mfma_f32_16x16x32_bf16 v[88:91], v[152:155], v[188:191], v[88:91]
    v_mfma_f32_16x16x32_bf16 v[92:95], v[156:159], v[188:191], v[92:95]
    v_mfma_f32_16x16x32_bf16 v[204:207], v[252:255], v[244:247], v[204:207]
    s_waitcnt lgkmcnt(11)
    v_mfma_f32_16x16x32_bf16 v[32:35], v[160:163], v[128:131], v[32:35]
    s_waitcnt lgkmcnt(10)
    v_mfma_f32_16x16x32_bf16 v[36:39], v[160:163], v[132:135], v[36:39]
    s_waitcnt lgkmcnt(0)
    s_barrier
    ds_read_b64_tr_b16 v[176:177], v194 offset:0
    v_mfma_f32_16x16x32_bf16 v[48:51], v[164:167], v[128:131], v[48:51]
    ds_read_b64_tr_b16 v[178:179], v194 offset:1024
    v_mfma_f32_16x16x32_bf16 v[52:55], v[164:167], v[132:135], v[52:55]
    ds_read_b128 v[144:147], v193 offset:57344
    v_mfma_f32_16x16x32_bf16 v[40:43], v[160:163], v[136:139], v[40:43]
    ds_read_b128 v[148:151], v193 offset:59392
    ds_read_b64_tr_b16 v[180:181], v196 offset:8192
    v_mfma_f32_16x16x32_bf16 v[44:47], v[160:163], v[140:143], v[44:47]
    ds_read_b64_tr_b16 v[182:183], v196 offset:9216
    v_mfma_f32_16x16x32_bf16 v[56:59], v[164:167], v[136:139], v[56:59]
    ds_read_b128 v[152:155], v193 offset:61440
    v_mfma_f32_16x16x32_bf16 v[60:63], v[164:167], v[140:143], v[60:63]
    ds_read_b128 v[156:159], v193 offset:63488
    v_mfma_f32_16x16x32_bf16 v[64:67], v[128:131], v[168:171], v[64:67]
    ds_read_b64_tr_b16 v[184:185], v196 offset:0
    ds_read_b64_tr_b16 v[186:187], v196 offset:1024
    v_mfma_f32_16x16x32_bf16 v[68:71], v[132:135], v[168:171], v[68:71]
    ds_read_b64_tr_b16 v[188:189], v194 offset:8192
    v_mfma_f32_16x16x32_bf16 v[72:75], v[136:139], v[168:171], v[72:75]
    ds_read_b64_tr_b16 v[190:191], v194 offset:9216
    v_mfma_f32_16x16x32_bf16 v[76:79], v[140:143], v[168:171], v[76:79]
    ds_read_b128 v[252:255], v8 offset:960
    ds_read_b128 v[244:247], v5 offset:57344
    v_mfma_f32_16x16x32_bf16 v[80:83], v[128:131], v[172:175], v[80:83]
    v_mfma_f32_16x16x32_bf16 v[84:87], v[132:135], v[172:175], v[84:87]
    v_mfma_f32_16x16x32_bf16 v[88:91], v[136:139], v[172:175], v[88:91]
    v_mfma_f32_16x16x32_bf16 v[92:95], v[140:143], v[172:175], v[92:95]
    v_mfma_f32_16x16x32_bf16 v[204:207], v[248:251], v[240:243], v[204:207]
    s_waitcnt lgkmcnt(11)
    v_mfma_f32_16x16x32_bf16 v[32:35], v[176:179], v[144:147], v[32:35]
    s_waitcnt lgkmcnt(10)
    v_mfma_f32_16x16x32_bf16 v[36:39], v[176:179], v[148:151], v[36:39]
    s_waitcnt lgkmcnt(0)
    s_barrier
    v_mfma_f32_16x16x32_bf16 v[40:43], v[176:179], v[152:155], v[40:43]
    ds_read_b64_tr_b16 v[160:161], v198 offset:16384
    v_mfma_f32_16x16x32_bf16 v[44:47], v[176:179], v[156:159], v[44:47]
    ds_read_b64_tr_b16 v[162:163], v198 offset:16896
    v_mfma_f32_16x16x32_bf16 v[64:67], v[144:147], v[184:187], v[64:67]
    ds_read_b128 v[128:131], v192 offset:0
    v_mfma_f32_16x16x32_bf16 v[68:71], v[148:151], v[184:187], v[68:71]
    ds_read_b128 v[132:135], v192 offset:2048
    v_mfma_f32_16x16x32_bf16 v[72:75], v[152:155], v[184:187], v[72:75]
    ds_read_b64_tr_b16 v[164:165], v198 offset:24576
    v_mfma_f32_16x16x32_bf16 v[76:79], v[156:159], v[184:187], v[76:79]
    ds_read_b64_tr_b16 v[166:167], v198 offset:25088
    v_mfma_f32_16x16x32_bf16 v[80:83], v[144:147], v[188:191], v[80:83]
    ds_read_b128 v[136:139], v192 offset:4096
    s_lshl_b32 s60, s56, 17
    s_lshl_b32 s63, s54, 12
    v_mfma_f32_16x16x32_bf16 v[84:87], v[148:151], v[188:191], v[84:87]
    ds_read_b128 v[140:143], v192 offset:6144
    s_add_u32 s60, s60, s63
    v_pk_mul_f32 v[32:33], v[32:33], s[10:11]
    v_pk_mul_f32 v[34:35], v[34:35], s[10:11]
    v_mfma_f32_16x16x32_bf16 v[88:91], v[152:155], v[188:191], v[88:91]
    ds_read_b128 v[248:251], v8 offset:0
    v_pk_mul_f32 v[36:37], v[36:37], s[10:11]
    v_pk_mul_f32 v[38:39], v[38:39], s[10:11]
    v_cvt_pk_bf16_f32 v208, v32, v33
    v_mfma_f32_16x16x32_bf16 v[92:95], v[156:159], v[188:191], v[92:95]
    ds_read_b128 v[240:243], v4 offset:0
    v_cvt_pk_bf16_f32 v210, v36, v37
    v_cvt_pk_bf16_f32 v209, v34, v35
    v_cvt_pk_bf16_f32 v211, v38, v39
    v_mfma_f32_16x16x32_bf16 v[48:51], v[180:183], v[144:147], v[48:51]
    v_pk_mul_f32 v[40:41], v[40:41], s[10:11]
    v_pk_mul_f32 v[42:43], v[42:43], s[10:11]
    v_mfma_f32_16x16x32_bf16 v[52:55], v[180:183], v[148:151], v[52:55]
    v_pk_mul_f32 v[44:45], v[44:45], s[10:11]
    v_pk_mul_f32 v[46:47], v[46:47], s[10:11]
    v_cvt_pk_bf16_f32 v212, v40, v41
    v_mfma_f32_16x16x32_bf16 v[56:59], v[180:183], v[152:155], v[56:59]
    v_cvt_pk_bf16_f32 v214, v44, v45
    v_cvt_pk_bf16_f32 v213, v42, v43
    v_cvt_pk_bf16_f32 v215, v46, v47
    v_mfma_f32_16x16x32_bf16 v[60:63], v[180:183], v[156:159], v[60:63]
    v_permlane16_swap_b32 v208, v210
    v_permlane16_swap_b32 v209, v211
    v_permlane16_swap_b32 v212, v214
    v_mfma_f32_16x16x32_bf16 v[204:207], v[252:255], v[244:247], v[204:207]
    v_permlane16_swap_b32 v213, v215
    buffer_store_dwordx4 v[208:211], v2, s[32:35], s60 offen sc1
    buffer_store_dwordx4 v[212:215], v2, s[32:35], s60 offen offset:2048 sc1
    s_waitcnt lgkmcnt(7)
    v_mfma_f32_16x16x32_bf16 v[96:99], v[160:163], v[128:131], 0
    s_waitcnt lgkmcnt(6)
    v_mfma_f32_16x16x32_bf16 v[100:103], v[160:163], v[132:135], 0
    ds_read_b64_tr_b16 v[168:169], v198 offset:20480
    v_cvt_pk_bf16_f32 v224, v64, v65
    v_cvt_pk_bf16_f32 v226, v80, v81
    v_cvt_pk_bf16_f32 v225, v66, v67
    v_cvt_pk_bf16_f32 v227, v82, v83
    v_cvt_pk_bf16_f32 v228, v68, v69
    v_cvt_pk_bf16_f32 v230, v84, v85
    v_cvt_pk_bf16_f32 v229, v70, v71
    s_waitcnt lgkmcnt(1)
    v_mfma_f32_16x16x32_bf16 v[204:207], v[248:251], v[240:243], v[204:207]
    ds_read_b64_tr_b16 v[170:171], v198 offset:20992
    ds_read_b128 v[144:147], v193 offset:0
    v_cvt_pk_bf16_f32 v231, v86, v87
    v_permlane16_swap_b32 v224, v226
    v_permlane16_swap_b32 v225, v227
    v_permlane16_swap_b32 v228, v230
    v_permlane16_swap_b32 v229, v231
    v_permlane32_swap_b32 v224, v226
    v_permlane32_swap_b32 v225, v227
    v_permlane32_swap_b32 v228, v230
    v_mfma_f32_16x16x32_bf16 v[112:115], v[164:167], v[128:131], 0
    ds_read_b128 v[148:151], v193 offset:2048
    v_permlane32_swap_b32 v229, v231
    buffer_store_dwordx4 v[224:227], v200, s[32:35], s60 offen offset:1024 sc1
    buffer_store_dwordx4 v[228:231], v200, s[32:35], s60 offen offset:1536 sc1
    v_cvt_pk_bf16_f32 v232, v72, v73
    v_cvt_pk_bf16_f32 v234, v88, v89
    v_cvt_pk_bf16_f32 v233, v74, v75
    v_cvt_pk_bf16_f32 v235, v90, v91
    v_cvt_pk_bf16_f32 v236, v76, v77
    v_mfma_f32_16x16x32_bf16 v[116:119], v[164:167], v[132:135], 0
    ds_read_b64_tr_b16 v[172:173], v198 offset:28672
    ds_read_b64_tr_b16 v[174:175], v198 offset:29184
    v_cvt_pk_bf16_f32 v238, v92, v93
    v_cvt_pk_bf16_f32 v237, v78, v79
    v_cvt_pk_bf16_f32 v239, v94, v95
    v_permlane16_swap_b32 v232, v234
    v_permlane16_swap_b32 v233, v235
    v_permlane16_swap_b32 v236, v238
    v_permlane16_swap_b32 v237, v239
    v_permlane32_swap_b32 v232, v234
    v_mfma_f32_16x16x32_bf16 v[104:107], v[160:163], v[136:139], 0
    ds_read_b128 v[152:155], v193 offset:4096
    ds_read_b128 v[156:159], v193 offset:6144
    v_permlane32_swap_b32 v233, v235
    v_permlane32_swap_b32 v236, v238
    v_permlane32_swap_b32 v237, v239
    buffer_store_dwordx4 v[232:235], v200, s[32:35], s60 offen offset:3072 sc1
    buffer_store_dwordx4 v[236:239], v200, s[32:35], s60 offen offset:3584 sc1
    s_lshl_b32 s60, s56, 15
    s_lshl_b32 s63, s54, 10
    v_mfma_f32_16x16x32_bf16 v[108:111], v[160:163], v[140:143], 0
    s_add_u32 s60, s60, s63
    s_add_u32 s60, s60, 4194304
    buffer_store_dwordx4 v[236:239], v201, s[32:35], s60 offen offset:512 sc1
    v_pk_mul_f32 v[56:57], v[56:57], s[10:11]
    v_pk_mul_f32 v[58:59], v[58:59], s[10:11]
    v_pk_mul_f32 v[60:61], v[60:61], s[10:11]
    v_pk_mul_f32 v[62:63], v[62:63], s[10:11]
    v_cvt_pk_bf16_f32 v244, v56, v57
    v_mfma_f32_16x16x32_bf16 v[120:123], v[164:167], v[136:139], 0
    v_cvt_pk_bf16_f32 v246, v60, v61
    v_cvt_pk_bf16_f32 v245, v58, v59
    v_cvt_pk_bf16_f32 v247, v62, v63
    v_pk_mul_f32 v[48:49], v[48:49], s[10:11]
    v_pk_mul_f32 v[50:51], v[50:51], s[10:11]
    v_pk_mul_f32 v[52:53], v[52:53], s[10:11]
    v_pk_mul_f32 v[54:55], v[54:55], s[10:11]
    v_cvt_pk_bf16_f32 v240, v48, v49
    v_mfma_f32_16x16x32_bf16 v[124:127], v[164:167], v[140:143], 0
    v_cvt_pk_bf16_f32 v242, v52, v53
    v_cvt_pk_bf16_f32 v241, v50, v51
    v_cvt_pk_bf16_f32 v243, v54, v55
    v_permlane16_swap_b32 v244, v246
    v_permlane16_swap_b32 v245, v247
    buffer_store_dwordx4 v[244:247], v201, s[32:35], s60 offen sc1
    v_permlane16_swap_b32 v240, v242
    v_permlane16_swap_b32 v241, v243
    s_waitcnt lgkmcnt(5)
    v_mfma_f32_16x16x32_bf16 v[96:99], v[168:171], v[144:147], v[96:99]
    s_waitcnt lgkmcnt(4)
    v_mfma_f32_16x16x32_bf16 v[100:103], v[168:171], v[148:151], v[100:103]
    s_waitcnt lgkmcnt(0)
    s_barrier
    ds_read_b64_tr_b16 v[160:161], v198 offset:32768
    ds_read_b64_tr_b16 v[162:163], v198 offset:33280
    v_mfma_f32_16x16x32_bf16 v[112:115], v[172:175], v[144:147], v[112:115]
    ds_read_b128 v[128:131], v192 offset:8192
    ds_read_b128 v[132:135], v192 offset:10240
    v_mfma_f32_16x16x32_bf16 v[116:119], v[172:175], v[148:151], v[116:119]
    ds_read_b64_tr_b16 v[164:165], v198 offset:40960
    ds_read_b64_tr_b16 v[166:167], v198 offset:41472
    v_mfma_f32_16x16x32_bf16 v[104:107], v[168:171], v[152:155], v[104:107]
    ds_read_b128 v[136:139], v192 offset:12288
    ds_read_b128 v[140:143], v192 offset:14336
    v_mfma_f32_16x16x32_bf16 v[108:111], v[168:171], v[156:159], v[108:111]
    v_mfma_f32_16x16x32_bf16 v[120:123], v[172:175], v[152:155], v[120:123]
    v_mfma_f32_16x16x32_bf16 v[124:127], v[172:175], v[156:159], v[124:127]
    s_waitcnt lgkmcnt(5)
    v_mfma_f32_16x16x32_bf16 v[96:99], v[160:163], v[128:131], v[96:99]
    s_waitcnt lgkmcnt(4)
    v_mfma_f32_16x16x32_bf16 v[100:103], v[160:163], v[132:135], v[100:103]
    ds_read_b64_tr_b16 v[168:169], v198 offset:36864
    ds_read_b64_tr_b16 v[170:171], v198 offset:37376
    s_waitcnt lgkmcnt(4)
    v_mfma_f32_16x16x32_bf16 v[112:115], v[164:167], v[128:131], v[112:115]
    ds_read_b128 v[144:147], v193 offset:8192
    ds_read_b128 v[148:151], v193 offset:10240
    v_mfma_f32_16x16x32_bf16 v[116:119], v[164:167], v[132:135], v[116:119]
    ds_read_b64_tr_b16 v[172:173], v198 offset:45056
    ds_read_b64_tr_b16 v[174:175], v198 offset:45568
    s_waitcnt lgkmcnt(7)
    v_mfma_f32_16x16x32_bf16 v[104:107], v[160:163], v[136:139], v[104:107]
    ds_read_b128 v[152:155], v193 offset:12288
    ds_read_b128 v[156:159], v193 offset:14336
    s_waitcnt lgkmcnt(8)
    v_mfma_f32_16x16x32_bf16 v[108:111], v[160:163], v[140:143], v[108:111]
    v_mfma_f32_16x16x32_bf16 v[120:123], v[164:167], v[136:139], v[120:123]
    v_mfma_f32_16x16x32_bf16 v[124:127], v[164:167], v[140:143], v[124:127]
    s_waitcnt lgkmcnt(5)
    v_mfma_f32_16x16x32_bf16 v[96:99], v[168:171], v[144:147], v[96:99]
    s_waitcnt lgkmcnt(4)
    v_mfma_f32_16x16x32_bf16 v[100:103], v[168:171], v[148:151], v[100:103]
    s_waitcnt lgkmcnt(0)
    s_barrier
    ds_read_b64_tr_b16 v[160:161], v198 offset:49152
    ds_read_b64_tr_b16 v[162:163], v198 offset:49664
    v_mfma_f32_16x16x32_bf16 v[112:115], v[172:175], v[144:147], v[112:115]
    ds_read_b128 v[128:131], v192 offset:16384
    ds_read_b128 v[132:135], v192 offset:18432
    v_mfma_f32_16x16x32_bf16 v[116:119], v[172:175], v[148:151], v[116:119]
    ds_read_b64_tr_b16 v[164:165], v198 offset:57344
    ds_read_b64_tr_b16 v[166:167], v198 offset:57856
    v_mfma_f32_16x16x32_bf16 v[104:107], v[168:171], v[152:155], v[104:107]
    ds_read_b128 v[136:139], v192 offset:20480
    ds_read_b128 v[140:143], v192 offset:22528
    v_mfma_f32_16x16x32_bf16 v[108:111], v[168:171], v[156:159], v[108:111]
    v_mfma_f32_16x16x32_bf16 v[120:123], v[172:175], v[152:155], v[120:123]
    v_mfma_f32_16x16x32_bf16 v[124:127], v[172:175], v[156:159], v[124:127]
    s_waitcnt lgkmcnt(5)
    v_mfma_f32_16x16x32_bf16 v[96:99], v[160:163], v[128:131], v[96:99]
    s_waitcnt lgkmcnt(4)
    v_mfma_f32_16x16x32_bf16 v[100:103], v[160:163], v[132:135], v[100:103]
    ds_read_b64_tr_b16 v[168:169], v198 offset:53248
    ds_read_b64_tr_b16 v[170:171], v198 offset:53760
    s_waitcnt lgkmcnt(4)
    v_mfma_f32_16x16x32_bf16 v[112:115], v[164:167], v[128:131], v[112:115]
    ds_read_b128 v[144:147], v193 offset:16384
    ds_read_b128 v[148:151], v193 offset:18432
    v_mfma_f32_16x16x32_bf16 v[116:119], v[164:167], v[132:135], v[116:119]
    ds_read_b64_tr_b16 v[172:173], v198 offset:61440
    ds_read_b64_tr_b16 v[174:175], v198 offset:61952
    s_waitcnt lgkmcnt(7)
    v_mfma_f32_16x16x32_bf16 v[104:107], v[160:163], v[136:139], v[104:107]
    ds_read_b128 v[152:155], v193 offset:20480
    ds_read_b128 v[156:159], v193 offset:22528
    s_waitcnt lgkmcnt(8)
    v_mfma_f32_16x16x32_bf16 v[108:111], v[160:163], v[140:143], v[108:111]
    v_mfma_f32_16x16x32_bf16 v[120:123], v[164:167], v[136:139], v[120:123]
    v_mfma_f32_16x16x32_bf16 v[124:127], v[164:167], v[140:143], v[124:127]
    s_waitcnt lgkmcnt(5)
    v_mfma_f32_16x16x32_bf16 v[96:99], v[168:171], v[144:147], v[96:99]
    s_waitcnt lgkmcnt(4)
    v_mfma_f32_16x16x32_bf16 v[100:103], v[168:171], v[148:151], v[100:103]
    s_waitcnt vmcnt(0)
    s_waitcnt lgkmcnt(0)
    s_barrier
    ds_read_b64_tr_b16 v[160:161], v199 offset:0
    ds_read_b64_tr_b16 v[162:163], v199 offset:512
    v_and_b32 v28, 11, v1
    v_mov_b32 v29, 0x3f803f80
    v_mfma_f32_16x16x32_bf16 v[112:115], v[172:175], v[144:147], v[112:115]
    ds_read_b128 v[128:131], v192 offset:24576
    ds_read_b128 v[132:135], v192 offset:26624
    v_cmp_eq_u32 vcc, 0, v28
    s_nop 1
    v_cndmask_b32 v28, 0, v29, vcc
    v_mfma_f32_16x16x32_bf16 v[116:119], v[172:175], v[148:151], v[116:119]
    ds_read_b64_tr_b16 v[164:165], v199 offset:8192
    ds_read_b64_tr_b16 v[166:167], v199 offset:8704
    v_mov_b32 v29, 0xf149f2ca
    v_mov_b32 v84, v28
    v_mfma_f32_16x16x32_bf16 v[104:107], v[168:171], v[152:155], v[104:107]
    ds_read_b128 v[136:139], v192 offset:28672
    ds_read_b128 v[140:143], v192 offset:30720
    v_mov_b32 v85, v28
    v_mov_b32 v86, v28
    v_mov_b32 v87, v28
    v_mfma_f32_16x16x32_bf16 v[108:111], v[168:171], v[156:159], v[108:111]
    v_cndmask_b32 v32, v224, v28, s[98:99]
    v_cndmask_b32 v33, v225, v28, s[98:99]
    v_mfma_f32_16x16x32_bf16 v[120:123], v[172:175], v[152:155], v[120:123]
    v_cndmask_b32 v34, v226, v28, s[98:99]
    v_cndmask_b32 v35, v227, v28, s[98:99]
    v_mfma_f32_16x16x32_bf16 v[124:127], v[172:175], v[156:159], v[124:127]
    v_cndmask_b32 v36, v228, v28, s[98:99]
    v_cndmask_b32 v37, v229, v28, s[98:99]
    v_cndmask_b32 v38, v230, v28, s[98:99]
    s_waitcnt lgkmcnt(5)
    v_mfma_f32_16x16x32_bf16 v[96:99], v[160:163], v[128:131], v[96:99]
    s_waitcnt lgkmcnt(4)
    v_mfma_f32_16x16x32_bf16 v[100:103], v[160:163], v[132:135], v[100:103]
    ds_read_b64_tr_b16 v[168:169], v199 offset:4096
    ds_read_b64_tr_b16 v[170:171], v199 offset:4608
    v_cndmask_b32 v39, v231, v28, s[98:99]
    v_cndmask_b32 v40, v232, v28, s[98:99]
    s_waitcnt lgkmcnt(4)
    v_mfma_f32_16x16x32_bf16 v[112:115], v[164:167], v[128:131], v[112:115]
    ds_read_b128 v[144:147], v193 offset:24576
    ds_read_b128 v[148:151], v193 offset:26624
    v_cndmask_b32 v41, v233, v28, s[98:99]
    v_cndmask_b32 v42, v234, v28, s[98:99]
    v_mfma_f32_16x16x32_bf16 v[116:119], v[164:167], v[132:135], v[116:119]
    ds_read_b64_tr_b16 v[172:173], v199 offset:12288
    ds_read_b64_tr_b16 v[174:175], v199 offset:12800
    v_cndmask_b32 v43, v235, v28, s[98:99]
    v_cndmask_b32 v44, v236, v28, s[98:99]
    s_waitcnt lgkmcnt(7)
    v_mfma_f32_16x16x32_bf16 v[104:107], v[160:163], v[136:139], v[104:107]
    ds_read_b128 v[152:155], v193 offset:28672
    ds_read_b128 v[156:159], v193 offset:30720
    v_cndmask_b32 v45, v237, v28, s[98:99]
    v_cndmask_b32 v46, v238, v28, s[98:99]
    v_cndmask_b32 v47, v239, v28, s[98:99]
    s_waitcnt lgkmcnt(8)
    v_mfma_f32_16x16x32_bf16 v[108:111], v[160:163], v[140:143], v[108:111]
    v_cndmask_b32 v224, v28, v224, s[98:99]
    v_cndmask_b32 v225, v28, v225, s[98:99]
    v_mfma_f32_16x16x32_bf16 v[120:123], v[164:167], v[136:139], v[120:123]
    v_cndmask_b32 v226, v28, v226, s[98:99]
    v_cndmask_b32 v227, v28, v227, s[98:99]
    v_mfma_f32_16x16x32_bf16 v[124:127], v[164:167], v[140:143], v[124:127]
    v_cndmask_b32 v228, v28, v228, s[98:99]
    v_cndmask_b32 v229, v28, v229, s[98:99]
    v_cndmask_b32 v230, v28, v230, s[98:99]
    s_waitcnt lgkmcnt(5)
    v_mfma_f32_16x16x32_bf16 v[96:99], v[168:171], v[144:147], v[96:99]
    s_waitcnt lgkmcnt(4)
    v_mfma_f32_16x16x32_bf16 v[100:103], v[168:171], v[148:151], v[100:103]
    s_waitcnt lgkmcnt(0)
    s_barrier
    ds_read_b64_tr_b16 v[160:161], v198 offset:0
    ds_read_b64_tr_b16 v[162:163], v198 offset:512
    v_cndmask_b32 v231, v28, v231, s[98:99]
    v_cndmask_b32 v232, v28, v232, s[98:99]
    v_mfma_f32_16x16x32_bf16 v[112:115], v[172:175], v[144:147], v[112:115]
    ds_read_b128 v[128:131], v192 offset:32768
    ds_read_b128 v[132:135], v192 offset:34816
    v_cndmask_b32 v233, v28, v233, s[98:99]
    v_cndmask_b32 v234, v28, v234, s[98:99]
    v_mfma_f32_16x16x32_bf16 v[116:119], v[172:175], v[148:151], v[116:119]
    ds_read_b64_tr_b16 v[164:165], v198 offset:8192
    ds_read_b64_tr_b16 v[166:167], v198 offset:8704
    v_cndmask_b32 v235, v28, v235, s[98:99]
    v_cndmask_b32 v236, v28, v236, s[98:99]
    v_mfma_f32_16x16x32_bf16 v[104:107], v[168:171], v[152:155], v[104:107]
    ds_read_b128 v[136:139], v192 offset:36864
    ds_read_b128 v[140:143], v192 offset:38912
    v_cndmask_b32 v237, v28, v237, s[98:99]
    v_cndmask_b32 v238, v28, v238, s[98:99]
    v_cndmask_b32 v239, v28, v239, s[98:99]
    v_mfma_f32_16x16x32_bf16 v[108:111], v[168:171], v[156:159], v[108:111]
    v_cndmask_b32 v64, v29, 0, s[64:65]
    v_cndmask_b32 v65, v29, 0, s[66:67]
    v_mfma_f32_16x16x32_bf16 v[120:123], v[172:175], v[152:155], v[120:123]
    v_cndmask_b32 v66, v29, 0, s[68:69]
    v_cndmask_b32 v67, v29, 0, s[70:71]
    v_mfma_f32_16x16x32_bf16 v[124:127], v[172:175], v[156:159], v[124:127]
    v_cndmask_b32 v68, v29, 0, s[72:73]
    v_cndmask_b32 v69, v29, 0, s[74:75]
    v_cndmask_b32 v70, v29, 0, s[76:77]
    s_waitcnt lgkmcnt(5)
    v_mfma_f32_16x16x32_bf16 v[96:99], v[160:163], v[128:131], v[96:99]
    s_waitcnt lgkmcnt(4)
    v_mfma_f32_16x16x32_bf16 v[100:103], v[160:163], v[132:135], v[100:103]
    ds_read_b64_tr_b16 v[168:169], v198 offset:4096
    ds_read_b64_tr_b16 v[170:171], v198 offset:4608
    v_cndmask_b32 v71, v29, 0, s[78:79]
    v_cndmask_b32 v72, v29, 0, s[80:81]
    s_waitcnt lgkmcnt(4)
    v_mfma_f32_16x16x32_bf16 v[112:115], v[164:167], v[128:131], v[112:115]
    ds_read_b128 v[144:147], v193 offset:32768
    ds_read_b128 v[148:151], v193 offset:34816
    v_cndmask_b32 v73, v29, 0, s[82:83]
    v_cndmask_b32 v74, v29, 0, s[84:85]
    v_mfma_f32_16x16x32_bf16 v[116:119], v[164:167], v[132:135], v[116:119]
    ds_read_b64_tr_b16 v[172:173], v198 offset:12288
    ds_read_b64_tr_b16 v[174:175], v198 offset:12800
    v_cndmask_b32 v75, v29, 0, s[86:87]
    v_cndmask_b32 v76, v29, 0, s[88:89]
    s_waitcnt lgkmcnt(7)
    v_mfma_f32_16x16x32_bf16 v[104:107], v[160:163], v[136:139], v[104:107]
    ds_read_b128 v[152:155], v193 offset:36864
    ds_read_b128 v[156:159], v193 offset:38912
    v_cndmask_b32 v77, v29, 0, s[90:91]
    v_cndmask_b32 v78, v29, 0, s[92:93]
    v_cndmask_b32 v79, v29, 0, s[94:95]
    s_waitcnt lgkmcnt(8)
    v_mfma_f32_16x16x32_bf16 v[108:111], v[160:163], v[140:143], v[108:111]
    v_bfe_i32 v176, v202, 0, 1
    v_bfe_i32 v177, v202, 1, 1
    v_mfma_f32_16x16x32_bf16 v[120:123], v[164:167], v[136:139], v[120:123]
    v_bfe_i32 v178, v202, 2, 1
    v_bfe_i32 v179, v202, 3, 1
    v_mfma_f32_16x16x32_bf16 v[124:127], v[164:167], v[140:143], v[124:127]
    v_bfe_i32 v180, v202, 8, 1
    v_bfe_i32 v181, v202, 9, 1
    v_bfe_i32 v182, v202, 10, 1
    s_waitcnt lgkmcnt(5)
    v_mfma_f32_16x16x32_bf16 v[96:99], v[168:171], v[144:147], v[96:99]
    s_waitcnt lgkmcnt(4)
    v_mfma_f32_16x16x32_bf16 v[100:103], v[168:171], v[148:151], v[100:103]
    s_waitcnt lgkmcnt(0)
    s_barrier
    ds_read_b64_tr_b16 v[160:161], v198 offset:16384
    ds_read_b64_tr_b16 v[162:163], v198 offset:16896
    v_bfe_i32 v183, v202, 11, 1
    v_bfe_i32 v184, v202, 16, 1
    v_mfma_f32_16x16x32_bf16 v[112:115], v[172:175], v[144:147], v[112:115]
    ds_read_b128 v[128:131], v192 offset:40960
    ds_read_b128 v[132:135], v192 offset:43008
    v_bfe_i32 v185, v202, 17, 1
    v_bfe_i32 v186, v202, 18, 1
    v_mfma_f32_16x16x32_bf16 v[116:119], v[172:175], v[148:151], v[116:119]
    ds_read_b64_tr_b16 v[164:165], v198 offset:24576
    ds_read_b64_tr_b16 v[166:167], v198 offset:25088
    v_bfe_i32 v187, v202, 19, 1
    v_bfe_i32 v188, v202, 24, 1
    v_mfma_f32_16x16x32_bf16 v[104:107], v[168:171], v[152:155], v[104:107]
    ds_read_b128 v[136:139], v192 offset:45056
    ds_read_b128 v[140:143], v192 offset:47104
    v_bfe_i32 v189, v202, 25, 1
    v_bfe_i32 v190, v202, 26, 1
    v_bfe_i32 v191, v202, 27, 1
    v_mfma_f32_16x16x32_bf16 v[108:111], v[168:171], v[156:159], v[108:111]
    v_and_b32 v176, v29, v176
    v_and_b32 v177, v29, v177
    v_mfma_f32_16x16x32_bf16 v[120:123], v[172:175], v[152:155], v[120:123]
    v_and_b32 v178, v29, v178
    v_and_b32 v179, v29, v179
    v_mfma_f32_16x16x32_bf16 v[124:127], v[172:175], v[156:159], v[124:127]
    v_and_b32 v180, v29, v180
    v_and_b32 v181, v29, v181
    v_and_b32 v182, v29, v182
    s_waitcnt lgkmcnt(5)
    v_mfma_f32_16x16x32_bf16 v[96:99], v[160:163], v[128:131], v[96:99]
    s_waitcnt lgkmcnt(4)
    v_mfma_f32_16x16x32_bf16 v[100:103], v[160:163], v[132:135], v[100:103]
    ds_read_b64_tr_b16 v[168:169], v198 offset:20480
    ds_read_b64_tr_b16 v[170:171], v198 offset:20992
    v_and_b32 v183, v29, v183
    s_waitcnt lgkmcnt(4)
    v_mfma_f32_16x16x32_bf16 v[112:115], v[164:167], v[128:131], v[112:115]
    ds_read_b128 v[144:147], v193 offset:40960
    ds_read_b128 v[148:151], v193 offset:43008
    v_and_b32 v184, v29, v184
    v_mfma_f32_16x16x32_bf16 v[116:119], v[164:167], v[132:135], v[116:119]
    ds_read_b64_tr_b16 v[172:173], v198 offset:28672
    ds_read_b64_tr_b16 v[174:175], v198 offset:29184
    v_and_b32 v185, v29, v185
    s_waitcnt lgkmcnt(7)
    v_mfma_f32_16x16x32_bf16 v[104:107], v[160:163], v[136:139], v[104:107]
    ds_read_b128 v[152:155], v193 offset:45056
    ds_read_b128 v[156:159], v193 offset:47104
    v_and_b32 v186, v29, v186
    v_and_b32 v187, v29, v187
    s_waitcnt lgkmcnt(8)
    v_mfma_f32_16x16x32_bf16 v[108:111], v[160:163], v[140:143], v[108:111]
    v_and_b32 v188, v29, v188
    v_mfma_f32_16x16x32_bf16 v[120:123], v[164:167], v[136:139], v[120:123]
    v_and_b32 v189, v29, v189
    v_mfma_f32_16x16x32_bf16 v[124:127], v[164:167], v[140:143], v[124:127]
    v_and_b32 v190, v29, v190
    v_and_b32 v191, v29, v191
    s_waitcnt lgkmcnt(5)
    v_mfma_f32_16x16x32_bf16 v[96:99], v[168:171], v[144:147], v[96:99]
    s_waitcnt lgkmcnt(4)
    v_mfma_f32_16x16x32_bf16 v[100:103], v[168:171], v[148:151], v[100:103]
    s_waitcnt lgkmcnt(0)
    s_barrier
    ds_read_b64_tr_b16 v[160:161], v198 offset:32768
    ds_read_b64_tr_b16 v[162:163], v198 offset:33280
    v_mfma_f32_16x16x32_bf16 v[112:115], v[172:175], v[144:147], v[112:115]
    ds_read_b128 v[128:131], v192 offset:49152
    ds_read_b128 v[132:135], v192 offset:51200
    v_mfma_f32_16x16x32_bf16 v[116:119], v[172:175], v[148:151], v[116:119]
    ds_read_b64_tr_b16 v[164:165], v198 offset:40960
    ds_read_b64_tr_b16 v[166:167], v198 offset:41472
    v_mfma_f32_16x16x32_bf16 v[104:107], v[168:171], v[152:155], v[104:107]
    ds_read_b128 v[136:139], v192 offset:53248
    ds_read_b128 v[140:143], v192 offset:55296
    v_mfma_f32_16x16x32_bf16 v[108:111], v[168:171], v[156:159], v[108:111]
    v_mfma_f32_16x16x32_bf16 v[120:123], v[172:175], v[152:155], v[120:123]
    v_mfma_f32_16x16x32_bf16 v[124:127], v[172:175], v[156:159], v[124:127]
    s_waitcnt lgkmcnt(5)
    v_mfma_f32_16x16x32_bf16 v[96:99], v[160:163], v[128:131], v[96:99]
    s_waitcnt lgkmcnt(4)
    v_mfma_f32_16x16x32_bf16 v[100:103], v[160:163], v[132:135], v[100:103]
    ds_read_b64_tr_b16 v[168:169], v198 offset:36864
    ds_read_b64_tr_b16 v[170:171], v198 offset:37376
    s_waitcnt lgkmcnt(4)
    v_mfma_f32_16x16x32_bf16 v[112:115], v[164:167], v[128:131], v[112:115]
    ds_read_b128 v[144:147], v193 offset:49152
    ds_read_b128 v[148:151], v193 offset:51200
    v_mfma_f32_16x16x32_bf16 v[116:119], v[164:167], v[132:135], v[116:119]
    ds_read_b64_tr_b16 v[172:173], v198 offset:45056
    ds_read_b64_tr_b16 v[174:175], v198 offset:45568
    s_waitcnt lgkmcnt(7)
    v_mfma_f32_16x16x32_bf16 v[104:107], v[160:163], v[136:139], v[104:107]
    ds_read_b128 v[152:155], v193 offset:53248
    ds_read_b128 v[156:159], v193 offset:55296
    s_waitcnt lgkmcnt(8)
    v_mfma_f32_16x16x32_bf16 v[108:111], v[160:163], v[140:143], v[108:111]
    v_mfma_f32_16x16x32_bf16 v[120:123], v[164:167], v[136:139], v[120:123]
    v_mfma_f32_16x16x32_bf16 v[124:127], v[164:167], v[140:143], v[124:127]
    ds_write_b32 v9, v204
    s_waitcnt lgkmcnt(6)
    v_mfma_f32_16x16x32_bf16 v[96:99], v[168:171], v[144:147], v[96:99]
    s_waitcnt lgkmcnt(5)
    v_mfma_f32_16x16x32_bf16 v[100:103], v[168:171], v[148:151], v[100:103]
    s_waitcnt lgkmcnt(0)
    s_barrier
    ds_read_b64_tr_b16 v[160:161], v198 offset:49152
    ds_read_b64_tr_b16 v[162:163], v198 offset:49664
    v_mfma_f32_16x16x32_bf16 v[112:115], v[172:175], v[144:147], v[112:115]
    ds_read_b128 v[128:131], v192 offset:57344
    ds_read_b128 v[132:135], v192 offset:59392
    v_mfma_f32_16x16x32_bf16 v[116:119], v[172:175], v[148:151], v[116:119]
    ds_read_b64_tr_b16 v[164:165], v198 offset:57344
    ds_read_b64_tr_b16 v[166:167], v198 offset:57856
    v_mfma_f32_16x16x32_bf16 v[104:107], v[168:171], v[152:155], v[104:107]
    ds_read_b128 v[136:139], v192 offset:61440
    ds_read_b128 v[140:143], v192 offset:63488
    s_lshl_b32 s60, s56, 15
    s_lshl_b32 s63, s54, 10
    s_add_u32 s60, s60, s63
    s_add_u32 s60, s60, 4193280
    s_cmp_eq_u32 s54, 0
    s_cselect_b32 s60, 16777216, s60
    buffer_load_dwordx4 v[80:83], v201, s[32:35], s60 offen sc1
    s_not_b64 exec, s[98:99]
    buffer_load_dwordx4 v[84:87], v201, s[32:35], s60 offen offset:512 sc1
    s_mov_b64 exec, -1
    v_mfma_f32_16x16x32_bf16 v[108:111], v[168:171], v[156:159], v[108:111]
    v_mfma_f32_16x16x32_bf16 v[120:123], v[172:175], v[152:155], v[120:123]
    v_mfma_f32_16x16x32_bf16 v[124:127], v[172:175], v[156:159], v[124:127]
    s_waitcnt lgkmcnt(5)
    v_mfma_f32_16x16x32_bf16 v[96:99], v[160:163], v[128:131], v[96:99]
    s_waitcnt lgkmcnt(4)
    v_mfma_f32_16x16x32_bf16 v[100:103], v[160:163], v[132:135], v[100:103]
    ds_read_b64_tr_b16 v[168:169], v198 offset:53248
    ds_read_b64_tr_b16 v[170:171], v198 offset:53760
    s_waitcnt lgkmcnt(4)
    v_mfma_f32_16x16x32_bf16 v[112:115], v[164:167], v[128:131], v[112:115]
    ds_read_b128 v[144:147], v193 offset:57344
    ds_read_b128 v[148:151], v193 offset:59392
    v_mfma_f32_16x16x32_bf16 v[116:119], v[164:167], v[132:135], v[116:119]
    ds_read_b64_tr_b16 v[172:173], v198 offset:61440
    ds_read_b64_tr_b16 v[174:175], v198 offset:61952
    s_waitcnt lgkmcnt(7)
    v_mfma_f32_16x16x32_bf16 v[104:107], v[160:163], v[136:139], v[104:107]
    ds_read_b128 v[152:155], v193 offset:61440
    ds_read_b128 v[156:159], v193 offset:63488
    s_waitcnt lgkmcnt(8)
    v_mfma_f32_16x16x32_bf16 v[108:111], v[160:163], v[140:143], v[108:111]
    v_mfma_f32_16x16x32_bf16 v[120:123], v[164:167], v[136:139], v[120:123]
    v_mfma_f32_16x16x32_bf16 v[124:127], v[164:167], v[140:143], v[124:127]
    s_waitcnt lgkmcnt(2)
    v_mfma_f32_16x16x32_bf16 v[112:115], v[172:175], v[144:147], v[112:115]
    v_mfma_f32_16x16x32_bf16 v[116:119], v[172:175], v[148:151], v[116:119]
    s_waitcnt lgkmcnt(0)
    s_barrier
    ds_read_b32 v88, v13 offset:0
    ds_read_b32 v89, v13 offset:128
    v_mfma_f32_16x16x32_bf16 v[120:123], v[172:175], v[152:155], v[120:123]
    v_mfma_f32_16x16x32_bf16 v[124:127], v[172:175], v[156:159], v[124:127]
    s_waitcnt lgkmcnt(1)
    v_mul_f32 v88, 0xbfb8aa3b, v88
    s_waitcnt lgkmcnt(0)
    v_mul_f32 v89, 0xbfb8aa3b, v89
    v_exp_f32 v88, v88
    v_exp_f32 v89, v89
    v_mfma_f32_16x16x32_bf16 v[96:99], v[168:171], v[144:147], v[96:99]
    v_add_f32 v88, 1.0, v88
    v_add_f32 v89, 1.0, v89
    v_rcp_f32 v14, v88
    v_rcp_f32 v15, v89
    v_mfma_f32_16x16x32_bf16 v[100:103], v[168:171], v[148:151], v[100:103]
    v_cvt_pk_bf16_f32 v248, v112, v113
    v_cvt_pk_bf16_f32 v250, v116, v117
    v_cvt_pk_bf16_f32 v249, v114, v115
    v_cvt_pk_bf16_f32 v251, v118, v119
    v_mfma_f32_16x16x32_bf16 v[104:107], v[168:171], v[152:155], v[104:107]
    v_cvt_pk_bf16_f32 v252, v120, v121
    v_cvt_pk_bf16_f32 v254, v124, v125
    v_cvt_pk_bf16_f32 v253, v122, v123
    v_cvt_pk_bf16_f32 v255, v126, v127
    v_mfma_f32_16x16x32_bf16 v[108:111], v[168:171], v[156:159], v[108:111]
    v_permlane16_swap_b32 v248, v250
    v_permlane16_swap_b32 v249, v251
    v_permlane16_swap_b32 v252, v254
    v_permlane16_swap_b32 v253, v255
    s_nop 1
    v_mfma_f32_32x32x16_bf16 v[48:63], v[244:247], v[252:255], v[176:191]
    v_cvt_pk_bf16_f32 v24, v96, v97
    v_cvt_pk_bf16_f32 v26, v100, v101
    v_cvt_pk_bf16_f32 v25, v98, v99
    v_cvt_pk_bf16_f32 v27, v102, v103
    s_waitcnt vmcnt(1)
    v_mfma_f32_32x32x16_bf16 v[128:143], v[80:83], v[248:251], v[176:191]
    v_cvt_pk_bf16_f32 v216, v104, v105
    v_cvt_pk_bf16_f32 v218, v108, v109
    v_cvt_pk_bf16_f32 v217, v106, v107
    v_cvt_pk_bf16_f32 v219, v110, v111
    v_mfma_f32_32x32x16_bf16 v[96:111], v[240:243], v[248:251], v[176:191]
    v_permlane16_swap_b32 v24, v26
    v_permlane16_swap_b32 v25, v27
    v_permlane16_swap_b32 v216, v218
    v_permlane16_swap_b32 v217, v219
    v_mfma_f32_32x32x16_bf16 v[112:127], v[240:243], v[252:255], v[176:191]
    s_nop 6
    v_cndmask_b32 v104, v104, v136, s[98:99]
    v_cndmask_b32 v105, v105, v137, s[98:99]
    v_cndmask_b32 v106, v106, v138, s[98:99]
    s_nop 1
    v_cndmask_b32 v56, v56, v120, s[98:99]
    v_cndmask_b32 v107, v107, v139, s[98:99]
    v_cndmask_b32 v57, v57, v121, s[98:99]
    v_cndmask_b32 v108, v108, v140, s[98:99]
    v_cndmask_b32 v58, v58, v122, s[98:99]
    v_cndmask_b32 v109, v109, v141, s[98:99]
    v_cndmask_b32 v59, v59, v123, s[98:99]
    v_cndmask_b32 v110, v110, v142, s[98:99]
    v_cndmask_b32 v60, v60, v124, s[98:99]
    v_cndmask_b32 v111, v111, v143, s[98:99]
    v_cndmask_b32 v61, v61, v125, s[98:99]
    s_cmp_eq_u32 s54, 0
    s_cbranch_scc1 L_nohalo
L_halo:
    v_cndmask_b32 v62, v62, v126, s[98:99]
    v_max3_f32 v28, v96, v97, v98
    v_cndmask_b32 v63, v63, v127, s[98:99]
    v_max3_f32 v28, v28, v99, v100
    v_max3_f32 v30, v48, v49, v50
    v_max3_f32 v28, v28, v101, v102
    v_max3_f32 v30, v30, v51, v52
    v_max3_f32 v28, v28, v103, v104
    v_max3_f32 v30, v30, v53, v54
    v_max3_f32 v28, v28, v105, v106
    v_max3_f32 v30, v30, v55, v56
    v_max3_f32 v28, v28, v107, v108
    v_max3_f32 v30, v30, v57, v58
    v_max3_f32 v28, v28, v109, v110
    v_max3_f32 v30, v30, v59, v60
    v_max_f32 v28, v28, v111
    v_max3_f32 v30, v30, v61, v62
    v_mov_b32 v29, v28
    v_max_f32 v30, v30, v63
    s_nop 0
    v_permlane32_swap_b32 v28, v29
    v_mov_b32 v31, v30
    v_max_f32 v28, v28, v29
    s_nop 0
    v_permlane32_swap_b32 v30, v31
    v_pk_add_f32 v[96:97], v[96:97], v[28:29] op_sel_hi:[1,0] neg_lo:[0,1] neg_hi:[0,1]
    v_max_f32 v30, v30, v31
    v_pk_add_f32 v[98:99], v[98:99], v[28:29] op_sel_hi:[1,0] neg_lo:[0,1] neg_hi:[0,1]
    v_pk_add_f32 v[48:49], v[48:49], v[30:31] op_sel_hi:[1,0] neg_lo:[0,1] neg_hi:[0,1]
    v_pk_add_f32 v[100:101], v[100:101], v[28:29] op_sel_hi:[1,0] neg_lo:[0,1] neg_hi:[0,1]
    v_pk_add_f32 v[50:51], v[50:51], v[30:31] op_sel_hi:[1,0] neg_lo:[0,1] neg_hi:[0,1]
    v_pk_add_f32 v[102:103], v[102:103], v[28:29] op_sel_hi:[1,0] neg_lo:[0,1] neg_hi:[0,1]
    v_pk_add_f32 v[52:53], v[52:53], v[30:31] op_sel_hi:[1,0] neg_lo:[0,1] neg_hi:[0,1]
    v_pk_add_f32 v[104:105], v[104:105], v[28:29] op_sel_hi:[1,0] neg_lo:[0,1] neg_hi:[0,1]
    v_pk_add_f32 v[54:55], v[54:55], v[30:31] op_sel_hi:[1,0] neg_lo:[0,1] neg_hi:[0,1]
    v_pk_add_f32 v[106:107], v[106:107], v[28:29] op_sel_hi:[1,0] neg_lo:[0,1] neg_hi:[0,1]
    v_pk_add_f32 v[56:57], v[56:57], v[30:31] op_sel_hi:[1,0] neg_lo:[0,1] neg_hi:[0,1]
    v_pk_add_f32 v[108:109], v[108:109], v[28:29] op_sel_hi:[1,0] neg_lo:[0,1] neg_hi:[0,1]
    v_pk_add_f32 v[58:59], v[58:59], v[30:31] op_sel_hi:[1,0] neg_lo:[0,1] neg_hi:[0,1]
    v_pk_add_f32 v[110:111], v[110:111], v[28:29] op_sel_hi:[1,0] neg_lo:[0,1] neg_hi:[0,1]
    v_pk_add_f32 v[60:61], v[60:61], v[30:31] op_sel_hi:[1,0] neg_lo:[0,1] neg_hi:[0,1]
    v_exp_f32 v96, v96
    v_pk_add_f32 v[62:63], v[62:63], v[30:31] op_sel_hi:[1,0] neg_lo:[0,1] neg_hi:[0,1]
    v_exp_f32 v97, v97
    v_exp_f32 v48, v48
    v_exp_f32 v98, v98
    v_exp_f32 v49, v49
    v_exp_f32 v99, v99
    v_exp_f32 v50, v50
    v_exp_f32 v100, v100
    v_exp_f32 v51, v51
    v_exp_f32 v101, v101
    v_exp_f32 v52, v52
    v_exp_f32 v102, v102
    v_exp_f32 v53, v53
    v_exp_f32 v103, v103
    v_exp_f32 v54, v54
    v_exp_f32 v104, v104
    v_exp_f32 v55, v55
    v_exp_f32 v105, v105
    v_exp_f32 v56, v56
    v_exp_f32 v106, v106
    v_exp_f32 v57, v57
    v_exp_f32 v107, v107
    v_exp_f32 v58, v58
    v_exp_f32 v108, v108
    v_exp_f32 v59, v59
    v_exp_f32 v109, v109
    v_exp_f32 v60, v60
    v_exp_f32 v110, v110
    v_exp_f32 v61, v61
    v_exp_f32 v111, v111
    v_exp_f32 v62, v62
    v_cvt_pk_bf16_f32 v192, v96, v97
    v_exp_f32 v63, v63
    v_cvt_pk_bf16_f32 v193, v98, v99
    v_cvt_pk_bf16_f32 v200, v48, v49
    v_cvt_pk_bf16_f32 v194, v100, v101
    v_cvt_pk_bf16_f32 v201, v50, v51
    v_cvt_pk_bf16_f32 v195, v102, v103
    v_cvt_pk_bf16_f32 v202, v52, v53
    v_cvt_pk_bf16_f32 v196, v104, v105
    v_cvt_pk_bf16_f32 v203, v54, v55
    v_cvt_pk_bf16_f32 v197, v106, v107
    v_cvt_pk_bf16_f32 v204, v56, v57
    v_cvt_pk_bf16_f32 v198, v108, v109
    v_cvt_pk_bf16_f32 v205, v58, v59
    v_cvt_pk_bf16_f32 v199, v110, v111
    v_cvt_pk_bf16_f32 v206, v60, v61
    v_cndmask_b32 v88, 0, v196, s[98:99]
    v_mfma_f32_32x32x16_bf16 v[112:127], v[212:215], v[216:219], v[64:79]
    v_cvt_pk_bf16_f32 v207, v62, v63
    v_cndmask_b32 v89, 0, v197, s[98:99]
    v_cndmask_b32 v92, 0, v204, s[98:99]
    v_cndmask_b32 v90, 0, v198, s[98:99]
    v_cndmask_b32 v93, 0, v205, s[98:99]
    v_cndmask_b32 v91, 0, v199, s[98:99]
    v_mfma_f32_32x32x16_bf16 v[96:111], v[208:211], v[24:27], v[64:79]
    v_cndmask_b32 v94, 0, v206, s[98:99]
    v_cndmask_b32 v196, v196, 0, s[98:99]
    v_cndmask_b32 v95, 0, v207, s[98:99]
    v_cndmask_b32 v197, v197, 0, s[98:99]
    v_cndmask_b32 v204, v204, 0, s[98:99]
    v_cndmask_b32 v198, v198, 0, s[98:99]
    v_cndmask_b32 v205, v205, 0, s[98:99]
    v_cndmask_b32 v199, v199, 0, s[98:99]
    v_cndmask_b32 v206, v206, 0, s[98:99]
    v_cndmask_b32 v207, v207, 0, s[98:99]
    v_mfma_f32_32x32x16_bf16 v[160:175], v[32:35], v[192:195], 0
    v_max3_f32 v30, v112, v113, v114
    v_max3_f32 v28, v96, v97, v98
    v_max3_f32 v30, v30, v115, v116
    v_max3_f32 v28, v28, v99, v100
    v_mfma_f32_32x32x16_bf16 v[144:159], v[40:43], v[200:203], 0
    v_max3_f32 v30, v30, v117, v118
    v_max3_f32 v28, v28, v101, v102
    v_max3_f32 v30, v30, v119, v120
    v_max3_f32 v28, v28, v103, v104
    v_mfma_f32_32x32x16_bf16 v[160:175], v[36:39], v[196:199], v[160:175]
    v_max3_f32 v30, v30, v121, v122
    v_max3_f32 v28, v28, v105, v106
    v_max3_f32 v30, v30, v123, v124
    v_max3_f32 v28, v28, v107, v108
    v_mfma_f32_32x32x16_bf16 v[144:159], v[44:47], v[204:207], v[144:159]
    v_max3_f32 v30, v30, v125, v126
    v_max3_f32 v28, v28, v109, v110
    v_max_f32 v30, v30, v127
    v_max_f32 v28, v28, v111
    s_waitcnt vmcnt(0)
    v_mfma_f32_32x32x16_bf16 v[160:175], v[84:87], v[88:91], v[160:175]
    v_mov_b32 v31, v30
    v_mov_b32 v29, v28
    s_nop 0
    v_permlane32_swap_b32 v30, v31
    v_permlane32_swap_b32 v28, v29
    v_mfma_f32_32x32x16_bf16 v[144:159], v[36:39], v[92:95], v[144:159]
    v_max_f32 v30, v30, v31
    v_max_f32 v28, v28, v29
    v_pk_add_f32 v[64:65], 0, v[28:29] op_sel_hi:[0,0] neg_lo:[0,1] neg_hi:[0,1]
    v_pk_add_f32 v[66:67], 0, v[28:29] op_sel_hi:[0,0] neg_lo:[0,1] neg_hi:[0,1]
    v_pk_add_f32 v[68:69], 0, v[28:29] op_sel_hi:[0,0] neg_lo:[0,1] neg_hi:[0,1]
    v_pk_add_f32 v[70:71], 0, v[28:29] op_sel_hi:[0,0] neg_lo:[0,1] neg_hi:[0,1]
    v_pk_add_f32 v[72:73], 0, v[28:29] op_sel_hi:[0,0] neg_lo:[0,1] neg_hi:[0,1]
    v_pk_add_f32 v[74:75], 0, v[28:29] op_sel_hi:[0,0] neg_lo:[0,1] neg_hi:[0,1]
    v_pk_add_f32 v[76:77], 0, v[28:29] op_sel_hi:[0,0] neg_lo:[0,1] neg_hi:[0,1]
    v_pk_add_f32 v[78:79], 0, v[28:29] op_sel_hi:[0,0] neg_lo:[0,1] neg_hi:[0,1]
    v_rcp_f32 v200, v160
    s_nop 0
    v_rcp_f32 v202, v144
    v_sub_f32 v201, 1.0, v14
    v_sub_f32 v203, 1.0, v15
    v_mul_f32 v200, v200, v201
    v_mul_f32 v202, v202, v203
    v_mul_f32 v168, v200, v168
    v_mul_f32 v152, v202, v152
    v_mul_f32 v169, v200, v169
    v_mul_f32 v153, v202, v153
    v_mul_f32 v170, v200, v170
    v_mul_f32 v154, v202, v154
    v_mul_f32 v171, v200, v171
    v_mul_f32 v155, v202, v155
    v_mul_f32 v172, v200, v172
    v_mul_f32 v156, v202, v156
    v_mul_f32 v173, v200, v173
    v_mul_f32 v157, v202, v157
    v_mul_f32 v174, v200, v174
    v_mul_f32 v158, v202, v158
    v_mul_f32 v175, v200, v175
    v_mul_f32 v159, v202, v159
    v_cvt_pk_bf16_f32 v192, v168, v169
    v_cvt_pk_bf16_f32 v196, v152, v153
    v_cvt_pk_bf16_f32 v193, v170, v171
    v_cvt_pk_bf16_f32 v197, v154, v155
    v_cvt_pk_bf16_f32 v194, v172, v173
    v_cvt_pk_bf16_f32 v198, v156, v157
    v_cvt_pk_bf16_f32 v195, v174, v175
    v_cvt_pk_bf16_f32 v199, v158, v159
    s_lshl_b32 s60, s54, 17
    s_lshl_b32 s63, s56, 10
    s_add_u32 s60, s60, s63
    s_add_u32 s60, s60, 5308416
    buffer_store_dwordx4 v[192:195], v2, s[32:35], s60 offen sc1
    s_lshl_b32 s60, s54, 17
    s_lshl_b32 s63, s56, 10
    s_add_u32 s60, s60, s63
    s_add_u32 s60, s60, 5341184
    buffer_store_dwordx4 v[196:199], v2, s[32:35], s60 offen sc1
    v_pk_add_f32 v[80:81], 0, v[30:31] op_sel_hi:[0,0] neg_lo:[0,1] neg_hi:[0,1]
    v_pk_add_f32 v[82:83], 0, v[30:31] op_sel_hi:[0,0] neg_lo:[0,1] neg_hi:[0,1]
    v_pk_add_f32 v[84:85], 0, v[30:31] op_sel_hi:[0,0] neg_lo:[0,1] neg_hi:[0,1]
    v_pk_add_f32 v[86:87], 0, v[30:31] op_sel_hi:[0,0] neg_lo:[0,1] neg_hi:[0,1]
    v_pk_add_f32 v[88:89], 0, v[30:31] op_sel_hi:[0,0] neg_lo:[0,1] neg_hi:[0,1]
    v_pk_add_f32 v[90:91], 0, v[30:31] op_sel_hi:[0,0] neg_lo:[0,1] neg_hi:[0,1]
    v_pk_add_f32 v[92:93], 0, v[30:31] op_sel_hi:[0,0] neg_lo:[0,1] neg_hi:[0,1]
    v_pk_add_f32 v[94:95], 0, v[30:31] op_sel_hi:[0,0] neg_lo:[0,1] neg_hi:[0,1]
    s_nop 1
    v_mfma_f32_32x32x16_bf16 v[48:63], v[208:211], v[216:219], v[80:95]
    v_mfma_f32_32x32x16_bf16 v[96:111], v[208:211], v[24:27], v[64:79]
    s_barrier
    ds_read_b128 v[152:155], v10 offset:0
    ds_read_b128 v[156:159], v10 offset:8320
    ds_read_b128 v[192:195], v11 offset:1024
    ds_read_b128 v[196:199], v12 offset:1536
    ds_read_b128 v[200:203], v11 offset:9344
    ds_read_b128 v[204:207], v12 offset:9856
    s_nop 3
    v_exp_f32 v48, v48
    v_exp_f32 v49, v49
    v_exp_f32 v50, v50
    v_exp_f32 v51, v51
    s_waitcnt lgkmcnt(5)
    v_mfma_f32_32x32x16_bf16 v[32:47], v[152:155], v[24:27], v[64:79]
    ds_read_b128 v[152:155], v10 offset:16640
    v_exp_f32 v52, v52
    v_exp_f32 v53, v53
    v_exp_f32 v54, v54
    v_exp_f32 v55, v55
    v_cvt_pk_bf16_f32 v136, v48, v49
    v_cvt_pk_bf16_f32 v137, v50, v51
    v_cvt_pk_bf16_f32 v138, v52, v53
    v_cvt_pk_bf16_f32 v139, v54, v55
    v_mfma_f32_32x32x16_bf16 v[112:127], v[212:215], v[216:219], v[80:95]
    v_exp_f32 v56, v56
    v_exp_f32 v57, v57
    v_exp_f32 v58, v58
    v_exp_f32 v59, v59
    v_mfma_f32_32x32x16_bf16 v[176:191], v[224:227], v[136:139], 0
    v_exp_f32 v60, v60
    v_exp_f32 v61, v61
    v_exp_f32 v62, v62
    v_exp_f32 v63, v63
    v_cvt_pk_bf16_f32 v140, v56, v57
    v_cvt_pk_bf16_f32 v141, v58, v59
    v_cvt_pk_bf16_f32 v142, v60, v61
    v_cvt_pk_bf16_f32 v143, v62, v63
    v_cndmask_b32 v96, v32, v96, s[64:65]
    s_waitcnt lgkmcnt(5)
    v_mfma_f32_32x32x16_bf16 v[48:63], v[156:159], v[216:219], v[80:95]
    v_cndmask_b32 v97, v33, v97, s[66:67]
    v_cndmask_b32 v98, v34, v98, s[68:69]
    v_cndmask_b32 v99, v35, v99, s[70:71]
    v_cndmask_b32 v100, v36, v100, s[72:73]
    v_cndmask_b32 v101, v37, v101, s[74:75]
    v_cndmask_b32 v102, v38, v102, s[76:77]
    v_cndmask_b32 v103, v39, v103, s[78:79]
    v_cndmask_b32 v104, v40, v104, s[80:81]
    v_mfma_f32_32x32x16_bf16 v[176:191], v[228:231], v[140:143], v[176:191]
    v_cndmask_b32 v105, v41, v105, s[82:83]
    v_cndmask_b32 v106, v42, v106, s[84:85]
    v_cndmask_b32 v107, v43, v107, s[86:87]
    v_cndmask_b32 v108, v44, v108, s[88:89]
    v_cndmask_b32 v109, v45, v109, s[90:91]
    v_cndmask_b32 v110, v46, v110, s[92:93]
    v_cndmask_b32 v111, v47, v111, s[94:95]
    v_mfma_f32_32x32x16_bf16 v[32:47], v[156:159], v[24:27], v[64:79]
    ds_read_b128 v[156:159], v10 offset:24960
    v_exp_f32 v96, v96
    v_exp_f32 v97, v97
    v_exp_f32 v98, v98
    v_exp_f32 v99, v99
    v_exp_f32 v100, v100
    v_exp_f32 v101, v101
    v_exp_f32 v102, v102
    v_exp_f32 v103, v103
    v_exp_f32 v104, v104
    v_exp_f32 v105, v105
    v_exp_f32 v106, v106
    v_exp_f32 v107, v107
    v_exp_f32 v108, v108
    v_exp_f32 v109, v109
    v_exp_f32 v110, v110
    v_exp_f32 v111, v111
    v_cvt_pk_bf16_f32 v144, v96, v97
    v_cvt_pk_bf16_f32 v145, v98, v99
    v_cvt_pk_bf16_f32 v146, v100, v101
    v_cvt_pk_bf16_f32 v147, v102, v103
    v_cvt_pk_bf16_f32 v148, v104, v105
    v_cvt_pk_bf16_f32 v149, v106, v107
    v_cvt_pk_bf16_f32 v150, v108, v109
    v_cvt_pk_bf16_f32 v151, v110, v111
    v_and_b32 v128, v16, v144
    v_and_b32 v129, v17, v145
    v_and_b32 v130, v18, v146
    v_and_b32 v131, v19, v147
    v_and_b32 v132, v20, v148
    v_and_b32 v133, v21, v149
    v_and_b32 v134, v22, v150
    v_and_b32 v135, v23, v151
    v_xor_b32 v96, v144, v128
    v_xor_b32 v97, v145, v129
    v_xor_b32 v98, v146, v130
    v_xor_b32 v99, v147, v131
    v_xor_b32 v100, v148, v132
    v_xor_b32 v101, v149, v133
    v_xor_b32 v102, v150, v134
    v_xor_b32 v103, v151, v135
    v_cndmask_b32 v112, v48, v112, s[64:65]
    v_cndmask_b32 v113, v49, v113, s[66:67]
    v_mfma_f32_32x32x16_bf16 v[160:175], v[224:227], v[128:131], 0
    v_cndmask_b32 v114, v50, v114, s[68:69]
    v_cndmask_b32 v115, v51, v115, s[70:71]
    v_cndmask_b32 v116, v52, v116, s[72:73]
    v_cndmask_b32 v117, v53, v117, s[74:75]
    v_cndmask_b32 v118, v54, v118, s[76:77]
    v_cndmask_b32 v119, v55, v119, s[78:79]
    v_cndmask_b32 v120, v56, v120, s[80:81]
    v_cndmask_b32 v121, v57, v121, s[82:83]
    v_mfma_f32_32x32x16_bf16 v[160:175], v[228:231], v[132:135], v[160:175]
    v_cndmask_b32 v122, v58, v122, s[84:85]
    v_cndmask_b32 v123, v59, v123, s[86:87]
    v_cndmask_b32 v124, v60, v124, s[88:89]
    v_cndmask_b32 v125, v61, v125, s[90:91]
    v_cndmask_b32 v126, v62, v126, s[92:93]
    v_cndmask_b32 v127, v63, v127, s[94:95]
    s_waitcnt lgkmcnt(1)
    v_mfma_f32_32x32x16_bf16 v[48:63], v[152:155], v[216:219], v[80:95]
    v_exp_f32 v112, v112
    v_exp_f32 v113, v113
    v_exp_f32 v114, v114
    v_exp_f32 v115, v115
    v_exp_f32 v116, v116
    v_mfma_f32_32x32x16_bf16 v[160:175], v[192:195], v[96:99], v[160:175]
    v_exp_f32 v117, v117
    v_exp_f32 v118, v118
    v_exp_f32 v119, v119
    v_exp_f32 v120, v120
    v_exp_f32 v121, v121
    v_mfma_f32_32x32x16_bf16 v[160:175], v[196:199], v[100:103], v[160:175]
    ds_read_b128 v[192:195], v11 offset:17664
    ds_read_b128 v[196:199], v12 offset:18176
    v_exp_f32 v122, v122
    v_exp_f32 v123, v123
    v_exp_f32 v124, v124
    v_exp_f32 v125, v125
    v_exp_f32 v126, v126
    v_exp_f32 v127, v127
    v_cvt_pk_bf16_f32 v144, v112, v113
    v_cvt_pk_bf16_f32 v145, v114, v115
    v_cvt_pk_bf16_f32 v146, v116, v117
    v_cvt_pk_bf16_f32 v147, v118, v119
    v_cvt_pk_bf16_f32 v148, v120, v121
    v_cvt_pk_bf16_f32 v149, v122, v123
    v_cvt_pk_bf16_f32 v150, v124, v125
    v_cvt_pk_bf16_f32 v151, v126, v127
    v_and_b32 v136, v16, v144
    v_and_b32 v137, v17, v145
    v_and_b32 v138, v18, v146
    v_and_b32 v139, v19, v147
    v_and_b32 v140, v20, v148
    v_and_b32 v141, v21, v149
    v_and_b32 v142, v22, v150
    v_and_b32 v143, v23, v151
    v_xor_b32 v112, v144, v136
    v_xor_b32 v113, v145, v137
    v_xor_b32 v114, v146, v138
    v_xor_b32 v115, v147, v139
    v_xor_b32 v116, v148, v140
    v_xor_b32 v117, v149, v141
    v_xor_b32 v118, v150, v142
    v_xor_b32 v119, v151, v143
    v_exp_f32 v32, v32
    v_exp_f32 v33, v33
    v_mfma_f32_32x32x16_bf16 v[176:191], v[232:235], v[136:139], v[176:191]
    v_exp_f32 v34, v34
    v_exp_f32 v35, v35
    v_exp_f32 v36, v36
    v_mfma_f32_32x32x16_bf16 v[176:191], v[236:239], v[140:143], v[176:191]
    v_exp_f32 v37, v37
    v_exp_f32 v38, v38
    v_exp_f32 v39, v39
    v_mfma_f32_32x32x16_bf16 v[176:191], v[200:203], v[112:115], v[176:191]
    v_cvt_pk_bf16_f32 v128, v32, v33
    v_cvt_pk_bf16_f32 v129, v34, v35
    v_cvt_pk_bf16_f32 v130, v36, v37
    v_cvt_pk_bf16_f32 v131, v38, v39
    v_exp_f32 v40, v40
    v_exp_f32 v41, v41
    v_mfma_f32_32x32x16_bf16 v[176:191], v[204:207], v[116:119], v[176:191]
    v_exp_f32 v42, v42
    v_exp_f32 v43, v43
    v_exp_f32 v44, v44
    v_exp_f32 v45, v45
    v_mfma_f32_32x32x16_bf16 v[160:175], v[200:203], v[128:131], v[160:175]
    v_exp_f32 v46, v46
    v_exp_f32 v47, v47
    v_cvt_pk_bf16_f32 v132, v40, v41
    v_cvt_pk_bf16_f32 v133, v42, v43
    v_cvt_pk_bf16_f32 v134, v44, v45
    v_cvt_pk_bf16_f32 v135, v46, v47
    v_exp_f32 v48, v48
    v_exp_f32 v49, v49
    v_mfma_f32_32x32x16_bf16 v[160:175], v[204:207], v[132:135], v[160:175]
    ds_read_b128 v[200:203], v11 offset:25984
    ds_read_b128 v[204:207], v12 offset:26496
    v_exp_f32 v50, v50
    v_exp_f32 v51, v51
    v_exp_f32 v52, v52
    v_exp_f32 v53, v53
    v_mfma_f32_32x32x16_bf16 v[32:47], v[152:155], v[24:27], v[64:79]
    ds_read_b128 v[152:155], v10 offset:33280
    v_exp_f32 v54, v54
    v_exp_f32 v55, v55
    v_cvt_pk_bf16_f32 v136, v48, v49
    v_cvt_pk_bf16_f32 v137, v50, v51
    v_cvt_pk_bf16_f32 v138, v52, v53
    v_cvt_pk_bf16_f32 v139, v54, v55
    v_exp_f32 v56, v56
    v_exp_f32 v57, v57
    s_waitcnt lgkmcnt(4)
    v_mfma_f32_32x32x16_bf16 v[176:191], v[192:195], v[136:139], v[176:191]
    v_exp_f32 v58, v58
    v_exp_f32 v59, v59
    v_exp_f32 v60, v60
    v_exp_f32 v61, v61
    v_exp_f32 v62, v62
    v_exp_f32 v63, v63
    v_cvt_pk_bf16_f32 v140, v56, v57
    v_cvt_pk_bf16_f32 v141, v58, v59
    v_cvt_pk_bf16_f32 v142, v60, v61
    v_cvt_pk_bf16_f32 v143, v62, v63
    s_waitcnt vmcnt(0)
    s_barrier
    v_exp_f32 v32, v32
    v_exp_f32 v33, v33
    s_waitcnt lgkmcnt(3)
    v_mfma_f32_32x32x16_bf16 v[176:191], v[196:199], v[140:143], v[176:191]
    v_exp_f32 v34, v34
    v_exp_f32 v35, v35
    v_exp_f32 v36, v36
    v_exp_f32 v37, v37
    v_mfma_f32_32x32x16_bf16 v[48:63], v[156:159], v[216:219], v[80:95]
    v_exp_f32 v38, v38
    v_exp_f32 v39, v39
    v_cvt_pk_bf16_f32 v128, v32, v33
    v_cvt_pk_bf16_f32 v129, v34, v35
    v_cvt_pk_bf16_f32 v130, v36, v37
    v_cvt_pk_bf16_f32 v131, v38, v39
    v_exp_f32 v40, v40
    v_exp_f32 v41, v41
    v_mfma_f32_32x32x16_bf16 v[160:175], v[192:195], v[128:131], v[160:175]
    v_exp_f32 v42, v42
    v_exp_f32 v43, v43
    v_exp_f32 v44, v44
    v_exp_f32 v45, v45
    v_exp_f32 v46, v46
    v_exp_f32 v47, v47
    v_cvt_pk_bf16_f32 v132, v40, v41
    v_cvt_pk_bf16_f32 v133, v42, v43
    v_cvt_pk_bf16_f32 v134, v44, v45
    v_cvt_pk_bf16_f32 v135, v46, v47
    v_exp_f32 v48, v48
    v_exp_f32 v49, v49
    v_mfma_f32_32x32x16_bf16 v[160:175], v[196:199], v[132:135], v[160:175]
    ds_read_b128 v[192:195], v11 offset:34304
    ds_read_b128 v[196:199], v12 offset:34816
    v_exp_f32 v50, v50
    v_exp_f32 v51, v51
    v_exp_f32 v52, v52
    v_exp_f32 v53, v53
    v_mfma_f32_32x32x16_bf16 v[32:47], v[156:159], v[24:27], v[64:79]
    ds_read_b128 v[156:159], v10 offset:41600
    v_exp_f32 v54, v54
    v_exp_f32 v55, v55
    v_cvt_pk_bf16_f32 v136, v48, v49
    v_cvt_pk_bf16_f32 v137, v50, v51
    v_cvt_pk_bf16_f32 v138, v52, v53
    v_cvt_pk_bf16_f32 v139, v54, v55
    v_exp_f32 v56, v56
    v_exp_f32 v57, v57
    s_waitcnt lgkmcnt(5)
    v_mfma_f32_32x32x16_bf16 v[176:191], v[200:203], v[136:139], v[176:191]
    v_exp_f32 v58, v58
    v_exp_f32 v59, v59
    v_exp_f32 v60, v60
    v_exp_f32 v61, v61
    v_exp_f32 v62, v62
    v_exp_f32 v63, v63
    v_cvt_pk_bf16_f32 v140, v56, v57
    v_cvt_pk_bf16_f32 v141, v58, v59
    v_cvt_pk_bf16_f32 v142, v60, v61
    v_cvt_pk_bf16_f32 v143, v62, v63
    s_waitcnt lgkmcnt(0)
    s_barrier
    v_exp_f32 v32, v32
    v_exp_f32 v33, v33
    v_mfma_f32_32x32x16_bf16 v[176:191], v[204:207], v[140:143], v[176:191]
    v_exp_f32 v34, v34
    v_exp_f32 v35, v35
    v_exp_f32 v36, v36
    v_exp_f32 v37, v37
    v_mfma_f32_32x32x16_bf16 v[48:63], v[152:155], v[216:219], v[80:95]
    v_exp_f32 v38, v38
    v_exp_f32 v39, v39
    v_cvt_pk_bf16_f32 v128, v32, v33
    v_cvt_pk_bf16_f32 v129, v34, v35
    v_cvt_pk_bf16_f32 v130, v36, v37
    v_cvt_pk_bf16_f32 v131, v38, v39
    v_exp_f32 v40, v40
    v_exp_f32 v41, v41
    v_mfma_f32_32x32x16_bf16 v[160:175], v[200:203], v[128:131], v[160:175]
    v_exp_f32 v42, v42
    v_exp_f32 v43, v43
    v_exp_f32 v44, v44
    v_exp_f32 v45, v45
    v_exp_f32 v46, v46
    v_exp_f32 v47, v47
    v_cvt_pk_bf16_f32 v132, v40, v41
    v_cvt_pk_bf16_f32 v133, v42, v43
    v_cvt_pk_bf16_f32 v134, v44, v45
    v_cvt_pk_bf16_f32 v135, v46, v47
    v_exp_f32 v48, v48
    v_exp_f32 v49, v49
    v_mfma_f32_32x32x16_bf16 v[160:175], v[204:207], v[132:135], v[160:175]
    ds_read_b128 v[200:203], v11 offset:42624
    ds_read_b128 v[204:207], v12 offset:43136
    v_exp_f32 v50, v50
    v_exp_f32 v51, v51
    v_exp_f32 v52, v52
    v_exp_f32 v53, v53
    v_mfma_f32_32x32x16_bf16 v[32:47], v[152:155], v[24:27], v[64:79]
    ds_read_b128 v[152:155], v10 offset:49920
    v_exp_f32 v54, v54
    v_exp_f32 v55, v55
    v_cvt_pk_bf16_f32 v136, v48, v49
    v_cvt_pk_bf16_f32 v137, v50, v51
    v_cvt_pk_bf16_f32 v138, v52, v53
    v_cvt_pk_bf16_f32 v139, v54, v55
    v_exp_f32 v56, v56
    v_exp_f32 v57, v57
    v_mfma_f32_32x32x16_bf16 v[176:191], v[192:195], v[136:139], v[176:191]
    v_exp_f32 v58, v58
    v_exp_f32 v59, v59
    v_exp_f32 v60, v60
    v_exp_f32 v61, v61
    v_exp_f32 v62, v62
    v_exp_f32 v63, v63
    v_cvt_pk_bf16_f32 v140, v56, v57
    v_cvt_pk_bf16_f32 v141, v58, v59
    v_cvt_pk_bf16_f32 v142, v60, v61
    v_cvt_pk_bf16_f32 v143, v62, v63
    v_exp_f32 v32, v32
    v_exp_f32 v33, v33
    v_mfma_f32_32x32x16_bf16 v[176:191], v[196:199], v[140:143], v[176:191]
    v_exp_f32 v34, v34
    v_exp_f32 v35, v35
    v_exp_f32 v36, v36
    v_exp_f32 v37, v37
    v_mfma_f32_32x32x16_bf16 v[48:63], v[156:159], v[216:219], v[80:95]
    v_exp_f32 v38, v38
    v_exp_f32 v39, v39
    v_cvt_pk_bf16_f32 v128, v32, v33
    v_cvt_pk_bf16_f32 v129, v34, v35
    v_cvt_pk_bf16_f32 v130, v36, v37
    v_cvt_pk_bf16_f32 v131, v38, v39
    v_exp_f32 v40, v40
    v_exp_f32 v41, v41
    v_mfma_f32_32x32x16_bf16 v[160:175], v[192:195], v[128:131], v[160:175]
    v_exp_f32 v42, v42
    v_exp_f32 v43, v43
    v_exp_f32 v44, v44
    v_exp_f32 v45, v45
    v_exp_f32 v46, v46
    v_exp_f32 v47, v47
    v_cvt_pk_bf16_f32 v132, v40, v41
    v_cvt_pk_bf16_f32 v133, v42, v43
    v_cvt_pk_bf16_f32 v134, v44, v45
    v_cvt_pk_bf16_f32 v135, v46, v47
    v_exp_f32 v48, v48
    v_exp_f32 v49, v49
    v_mfma_f32_32x32x16_bf16 v[160:175], v[196:199], v[132:135], v[160:175]
    ds_read_b128 v[192:195], v11 offset:50944
    ds_read_b128 v[196:199], v12 offset:51456
    v_exp_f32 v50, v50
    v_exp_f32 v51, v51
    v_exp_f32 v52, v52
    v_exp_f32 v53, v53
    v_mfma_f32_32x32x16_bf16 v[32:47], v[156:159], v[24:27], v[64:79]
    ds_read_b128 v[156:159], v10 offset:58240
    v_exp_f32 v54, v54
    v_exp_f32 v55, v55
    v_cvt_pk_bf16_f32 v136, v48, v49
    v_cvt_pk_bf16_f32 v137, v50, v51
    v_cvt_pk_bf16_f32 v138, v52, v53
    v_cvt_pk_bf16_f32 v139, v54, v55
    v_exp_f32 v56, v56
    v_exp_f32 v57, v57
    s_waitcnt lgkmcnt(5)
    v_mfma_f32_32x32x16_bf16 v[176:191], v[200:203], v[136:139], v[176:191]
    v_exp_f32 v58, v58
    v_exp_f32 v59, v59
    v_exp_f32 v60, v60
    v_exp_f32 v61, v61
    v_exp_f32 v62, v62
    v_exp_f32 v63, v63
    v_cvt_pk_bf16_f32 v140, v56, v57
    v_cvt_pk_bf16_f32 v141, v58, v59
    v_cvt_pk_bf16_f32 v142, v60, v61
    v_cvt_pk_bf16_f32 v143, v62, v63
    v_exp_f32 v32, v32
    v_exp_f32 v33, v33
    s_waitcnt lgkmcnt(4)
    v_mfma_f32_32x32x16_bf16 v[176:191], v[204:207], v[140:143], v[176:191]
    v_exp_f32 v34, v34
    v_exp_f32 v35, v35
    v_exp_f32 v36, v36
    v_exp_f32 v37, v37
    s_waitcnt lgkmcnt(3)
    v_mfma_f32_32x32x16_bf16 v[48:63], v[152:155], v[216:219], v[80:95]
    v_exp_f32 v38, v38
    v_exp_f32 v39, v39
    v_cvt_pk_bf16_f32 v128, v32, v33
    v_cvt_pk_bf16_f32 v129, v34, v35
    v_cvt_pk_bf16_f32 v130, v36, v37
    v_cvt_pk_bf16_f32 v131, v38, v39
    v_exp_f32 v40, v40
    v_exp_f32 v41, v41
    v_mfma_f32_32x32x16_bf16 v[160:175], v[200:203], v[128:131], v[160:175]
    v_exp_f32 v42, v42
    v_exp_f32 v43, v43
    v_exp_f32 v44, v44
    v_exp_f32 v45, v45
    v_exp_f32 v46, v46
    v_exp_f32 v47, v47
    v_cvt_pk_bf16_f32 v132, v40, v41
    v_cvt_pk_bf16_f32 v133, v42, v43
    v_cvt_pk_bf16_f32 v134, v44, v45
    v_cvt_pk_bf16_f32 v135, v46, v47
    v_exp_f32 v48, v48
    v_exp_f32 v49, v49
    v_mfma_f32_32x32x16_bf16 v[160:175], v[204:207], v[132:135], v[160:175]
    ds_read_b128 v[200:203], v11 offset:59264
    ds_read_b128 v[204:207], v12 offset:59776
    v_exp_f32 v50, v50
    v_exp_f32 v51, v51
    v_exp_f32 v52, v52
    v_exp_f32 v53, v53
    v_mfma_f32_32x32x16_bf16 v[32:47], v[152:155], v[24:27], v[64:79]
    v_exp_f32 v54, v54
    v_exp_f32 v55, v55
    v_cvt_pk_bf16_f32 v136, v48, v49
    v_cvt_pk_bf16_f32 v137, v50, v51
    v_cvt_pk_bf16_f32 v138, v52, v53
    v_cvt_pk_bf16_f32 v139, v54, v55
    v_exp_f32 v56, v56
    v_exp_f32 v57, v57
    s_waitcnt lgkmcnt(4)
    v_mfma_f32_32x32x16_bf16 v[176:191], v[192:195], v[136:139], v[176:191]
    v_exp_f32 v58, v58
    v_exp_f32 v59, v59
    v_exp_f32 v60, v60
    v_exp_f32 v61, v61
    v_exp_f32 v62, v62
    v_exp_f32 v63, v63
    v_cvt_pk_bf16_f32 v140, v56, v57
    v_cvt_pk_bf16_f32 v141, v58, v59
    v_cvt_pk_bf16_f32 v142, v60, v61
    v_cvt_pk_bf16_f32 v143, v62, v63
    v_exp_f32 v32, v32
    v_exp_f32 v33, v33
    s_waitcnt lgkmcnt(3)
    v_mfma_f32_32x32x16_bf16 v[176:191], v[196:199], v[140:143], v[176:191]
    v_exp_f32 v34, v34
    v_exp_f32 v35, v35
    v_exp_f32 v36, v36
    v_exp_f32 v37, v37
    s_waitcnt lgkmcnt(2)
    v_mfma_f32_32x32x16_bf16 v[48:63], v[156:159], v[216:219], v[80:95]
    v_exp_f32 v38, v38
    v_exp_f32 v39, v39
    v_cvt_pk_bf16_f32 v128, v32, v33
    v_cvt_pk_bf16_f32 v129, v34, v35
    v_cvt_pk_bf16_f32 v130, v36, v37
    v_cvt_pk_bf16_f32 v131, v38, v39
    v_exp_f32 v40, v40
    v_exp_f32 v41, v41
    v_mfma_f32_32x32x16_bf16 v[160:175], v[192:195], v[128:131], v[160:175]
    v_exp_f32 v42, v42
    v_exp_f32 v43, v43
    v_exp_f32 v44, v44
    v_exp_f32 v45, v45
    v_exp_f32 v46, v46
    v_exp_f32 v47, v47
    v_cvt_pk_bf16_f32 v132, v40, v41
    v_cvt_pk_bf16_f32 v133, v42, v43
    v_cvt_pk_bf16_f32 v134, v44, v45
    v_cvt_pk_bf16_f32 v135, v46, v47
    v_exp_f32 v48, v48
    v_exp_f32 v49, v49
    v_mfma_f32_32x32x16_bf16 v[160:175], v[196:199], v[132:135], v[160:175]
    v_exp_f32 v50, v50
    v_exp_f32 v51, v51
    v_exp_f32 v52, v52
    v_exp_f32 v53, v53
    v_mfma_f32_32x32x16_bf16 v[32:47], v[156:159], v[24:27], v[64:79]
    v_exp_f32 v54, v54
    v_exp_f32 v55, v55
    v_cvt_pk_bf16_f32 v136, v48, v49
    v_cvt_pk_bf16_f32 v137, v50, v51
    v_cvt_pk_bf16_f32 v138, v52, v53
    v_cvt_pk_bf16_f32 v139, v54, v55
    v_exp_f32 v56, v56
    v_exp_f32 v57, v57
    s_waitcnt lgkmcnt(1)
    v_mfma_f32_32x32x16_bf16 v[176:191], v[200:203], v[136:139], v[176:191]
    v_exp_f32 v58, v58
    v_exp_f32 v59, v59
    v_exp_f32 v60, v60
    v_exp_f32 v61, v61
    v_exp_f32 v62, v62
    v_exp_f32 v63, v63
    v_cvt_pk_bf16_f32 v140, v56, v57
    v_cvt_pk_bf16_f32 v141, v58, v59
    v_cvt_pk_bf16_f32 v142, v60, v61
    v_cvt_pk_bf16_f32 v143, v62, v63
    v_exp_f32 v32, v32
    v_exp_f32 v33, v33
    s_waitcnt lgkmcnt(0)
    v_mfma_f32_32x32x16_bf16 v[176:191], v[204:207], v[140:143], v[176:191]
    v_exp_f32 v34, v34
    v_exp_f32 v35, v35
    v_exp_f32 v36, v36
    v_exp_f32 v37, v37
    v_exp_f32 v38, v38
    v_exp_f32 v39, v39
    v_cvt_pk_bf16_f32 v128, v32, v33
    v_cvt_pk_bf16_f32 v129, v34, v35
    v_cvt_pk_bf16_f32 v130, v36, v37
    v_cvt_pk_bf16_f32 v131, v38, v39
    v_exp_f32 v40, v40
    v_exp_f32 v41, v41
    v_mfma_f32_32x32x16_bf16 v[160:175], v[200:203], v[128:131], v[160:175]
    v_exp_f32 v42, v42
    v_exp_f32 v43, v43
    v_exp_f32 v44, v44
    v_exp_f32 v45, v45
    v_exp_f32 v46, v46
    v_exp_f32 v47, v47
    v_cvt_pk_bf16_f32 v132, v40, v41
    v_cvt_pk_bf16_f32 v133, v42, v43
    v_cvt_pk_bf16_f32 v134, v44, v45
    v_cvt_pk_bf16_f32 v135, v46, v47
    s_nop 1
    v_mfma_f32_32x32x16_bf16 v[160:175], v[204:207], v[132:135], v[160:175]
    s_mov_b32 s63, 0x7b800000
    v_add_f32 v30, abs(v176), abs(v184)
    v_add_f32 v31, abs(v177), abs(v178)
    v_add_f32 v31, v31, abs(v179)
    v_add_f32 v30, v30, abs(v180)
    v_add_f32 v31, v31, abs(v181)
    v_add_f32 v30, v30, abs(v182)
    v_add_f32 v31, v31, abs(v183)
    v_add_f32 v30, v30, v31
    s_nop 2
    v_add_f32 v28, abs(v160), abs(v168)
    v_add_f32 v29, abs(v161), abs(v162)
    v_add_f32 v29, v29, abs(v163)
    v_add_f32 v28, v28, abs(v164)
    v_add_f32 v29, v29, abs(v165)
    v_add_f32 v28, v28, abs(v166)
    v_add_f32 v29, v29, abs(v167)
    v_add_f32 v28, v28, v29
    v_add_f32 v28, v28, v30
    v_cmp_lt_f32 vcc, v28, s63
    s_nop 1
    s_cmp_eq_u64 vcc, -1
    s_cbranch_scc0 L_exact0
L_back:
    v_rcp_f32 v30, v184
    v_rcp_f32 v28, v168
    v_mul_f32 v30, v30, v15
    v_mul_f32 v28, v28, v14
    v_mul_f32 v176, v30, v176
    v_mul_f32 v160, v28, v160
    v_mul_f32 v177, v30, v177
    v_mul_f32 v161, v28, v161
    v_mul_f32 v178, v30, v178
    v_mul_f32 v162, v28, v162
    v_mul_f32 v179, v30, v179
    v_mul_f32 v163, v28, v163
    v_mul_f32 v180, v30, v180
    v_mul_f32 v164, v28, v164
    v_mul_f32 v181, v30, v181
    v_mul_f32 v165, v28, v165
    v_mul_f32 v182, v30, v182
    v_mul_f32 v166, v28, v166
    v_mul_f32 v183, v30, v183
    v_mul_f32 v167, v28, v167
    v_cvt_pk_bf16_f32 v148, v176, v177
    v_cvt_pk_bf16_f32 v144, v160, v161
    v_cvt_pk_bf16_f32 v149, v178, v179
    v_cvt_pk_bf16_f32 v145, v162, v163
    v_cvt_pk_bf16_f32 v150, v180, v181
    v_cvt_pk_bf16_f32 v146, v164, v165
    v_cvt_pk_bf16_f32 v151, v182, v183
    v_cvt_pk_bf16_f32 v147, v166, v167
    s_lshl_b32 s60, s54, 17
    s_lshl_b32 s63, s56, 10
    s_add_u32 s60, s60, s63
    s_add_u32 s60, s60, 5275648
    buffer_store_dwordx4 v[148:151], v2, s[32:35], s60 offen sc1
    s_lshl_b32 s60, s54, 17
    s_lshl_b32 s63, s56, 10
    s_add_u32 s60, s60, s63
    s_add_u32 s60, s60, 5242880
    buffer_store_dwordx4 v[144:147], v2, s[32:35], s60 offen sc1
    s_endpgm
L_end:
    s_endpgm
L_nohalo:
    v_mov_b32 v28, 0xf149f2ca
    v_cndmask_b32 v104, v104, v28, s[98:99]
    v_cndmask_b32 v105, v105, v28, s[98:99]
    v_cndmask_b32 v106, v106, v28, s[98:99]
    v_cndmask_b32 v107, v107, v28, s[98:99]
    v_cndmask_b32 v108, v108, v28, s[98:99]
    v_cndmask_b32 v109, v109, v28, s[98:99]
    v_cndmask_b32 v110, v110, v28, s[98:99]
    v_cndmask_b32 v111, v111, v28, s[98:99]
    s_branch L_halo
L_retry:
    s_mov_b32 s3, 0x20000
    s_nop 15
L_again:
    s_mov_b32 s63, 0
    buffer_load_dwordx4 v[192:195], v18, s[32:35], s63 offen sc1
    buffer_load_dwordx4 v[196:199], v18, s[32:35], s63 offen offset:1024 sc1
    buffer_load_dwordx4 v[200:203], v18, s[32:35], s63 offen offset:2048 sc1
    buffer_load_dwordx4 v[204:207], v18, s[32:35], s63 offen offset:3072 sc1
    s_mov_b32 s63, 4096
    buffer_load_dwordx4 v[208:211], v18, s[32:35], s63 offen sc1
    buffer_load_dwordx4 v[212:215], v18, s[32:35], s63 offen offset:1024 sc1
    buffer_load_dwordx4 v[216:219], v18, s[32:35], s63 offen offset:2048 sc1
    buffer_load_dwordx4 v[220:223], v18, s[32:35], s63 offen offset:3072 sc1
    s_mov_b32 s63, 8192
    buffer_load_dwordx4 v[224:227], v18, s[32:35], s63 offen sc1
    buffer_load_dwordx4 v[228:231], v18, s[32:35], s63 offen offset:1024 sc1
    buffer_load_dwordx4 v[232:235], v18, s[32:35], s63 offen offset:2048 sc1
    buffer_load_dwordx4 v[236:239], v18, s[32:35], s63 offen offset:3072 sc1
    s_mov_b32 s63, 12288
    buffer_load_dwordx4 v[240:243], v18, s[32:35], s63 offen sc1
    buffer_load_dwordx4 v[244:247], v18, s[32:35], s63 offen offset:1024 sc1
    buffer_load_dwordx4 v[248:251], v18, s[32:35], s63 offen offset:2048 sc1
    buffer_load_dwordx4 v[252:255], v18, s[32:35], s63 offen offset:3072 sc1
    s_sub_u32 s3, s3, 1
    s_waitcnt vmcnt(0)
    s_cbranch_scc1 L_redo
    v_max3_u32 v28, v192, v193, v193
    v_max3_u32 v28, v28, v194, v195
    v_max3_u32 v28, v28, v196, v197
    v_max3_u32 v28, v28, v198, v199
    v_max3_u32 v28, v28, v200, v201
    v_max3_u32 v28, v28, v202, v203
    v_max3_u32 v28, v28, v204, v205
    v_max3_u32 v28, v28, v206, v207
    v_max3_u32 v28, v28, v208, v209
    v_max3_u32 v28, v28, v210, v211
    v_max3_u32 v28, v28, v212, v213
    v_max3_u32 v28, v28, v214, v215
    v_max3_u32 v28, v28, v216, v217
    v_max3_u32 v28, v28, v218, v219
    v_max3_u32 v28, v28, v220, v221
    v_max3_u32 v28, v28, v222, v223
    v_max3_u32 v28, v28, v224, v225
    v_max3_u32 v28, v28, v226, v227
    v_max3_u32 v28, v28, v228, v229
    v_max3_u32 v28, v28, v230, v231
    v_max3_u32 v28, v28, v232, v233
    v_max3_u32 v28, v28, v234, v235
    v_max3_u32 v28, v28, v236, v237
    v_max3_u32 v28, v28, v238, v239
    v_max3_u32 v28, v28, v240, v241
    v_max3_u32 v28, v28, v242, v243
    v_max3_u32 v28, v28, v244, v245
    v_max3_u32 v28, v28, v246, v247
    v_max3_u32 v28, v28, v248, v249
    v_max3_u32 v28, v28, v250, v251
    v_max3_u32 v28, v28, v252, v253
    v_max3_u32 v28, v28, v254, v255
    v_cmp_ne_u32 vcc, -1, v28
    s_nop 1
    s_cmp_eq_u64 vcc, -1
    s_cbranch_scc0 L_again
L_redo:
    ds_read_b64_tr_b16 v[176:177], v24 offset:0
    ds_read_b64_tr_b16 v[178:179], v24 offset:1024
    ds_read_b64_tr_b16 v[180:181], v25 offset:0
    ds_read_b64_tr_b16 v[182:183], v25 offset:1024
    s_waitcnt lgkmcnt(2)
    v_mfma_f32_32x32x16_bf16 v[64:79], v[176:179], v[192:195], v[32:47]
    ds_read_b64_tr_b16 v[184:185], v24 offset:2048
    ds_read_b64_tr_b16 v[186:187], v24 offset:3072
    s_waitcnt lgkmcnt(2)
    v_mfma_f32_32x32x16_bf16 v[80:95], v[180:183], v[192:195], v[48:63]
    ds_read_b64_tr_b16 v[188:189], v25 offset:2048
    ds_read_b64_tr_b16 v[190:191], v25 offset:3072
    s_waitcnt lgkmcnt(2)
    v_mfma_f32_32x32x16_bf16 v[64:79], v[184:187], v[196:199], v[64:79]
    ds_read_b64_tr_b16 v[176:177], v24 offset:4096
    ds_read_b64_tr_b16 v[178:179], v24 offset:5120
    s_waitcnt lgkmcnt(2)
    v_mfma_f32_32x32x16_bf16 v[80:95], v[188:191], v[196:199], v[80:95]
    ds_read_b64_tr_b16 v[180:181], v25 offset:4096
    ds_read_b64_tr_b16 v[182:183], v25 offset:5120
    s_waitcnt lgkmcnt(2)
    v_mfma_f32_32x32x16_bf16 v[64:79], v[176:179], v[200:203], v[64:79]
    ds_read_b64_tr_b16 v[184:185], v26 offset:0
    ds_read_b64_tr_b16 v[186:187], v26 offset:1024
    s_waitcnt lgkmcnt(2)
    v_mfma_f32_32x32x16_bf16 v[80:95], v[180:183], v[200:203], v[80:95]
    ds_read_b64_tr_b16 v[188:189], v27 offset:0
    ds_read_b64_tr_b16 v[190:191], v27 offset:1024
    s_waitcnt lgkmcnt(2)
    v_mfma_f32_32x32x16_bf16 v[64:79], v[184:187], v[204:207], v[64:79]
    ds_read_b64_tr_b16 v[176:177], v26 offset:2048
    ds_read_b64_tr_b16 v[178:179], v26 offset:3072
    s_waitcnt lgkmcnt(2)
    v_mfma_f32_32x32x16_bf16 v[80:95], v[188:191], v[204:207], v[80:95]
    ds_read_b64_tr_b16 v[180:181], v27 offset:2048
    ds_read_b64_tr_b16 v[182:183], v27 offset:3072
    s_waitcnt lgkmcnt(2)
    v_mfma_f32_32x32x16_bf16 v[64:79], v[176:179], v[208:211], v[64:79]
    ds_read_b64_tr_b16 v[184:185], v26 offset:4096
    ds_read_b64_tr_b16 v[186:187], v26 offset:5120
    s_waitcnt lgkmcnt(2)
    v_mfma_f32_32x32x16_bf16 v[80:95], v[180:183], v[208:211], v[80:95]
    ds_read_b64_tr_b16 v[188:189], v27 offset:4096
    ds_read_b64_tr_b16 v[190:191], v27 offset:5120
    s_waitcnt lgkmcnt(2)
    v_mfma_f32_32x32x16_bf16 v[64:79], v[184:187], v[212:215], v[64:79]
    ds_read_b64_tr_b16 v[176:177], v26 offset:6144
    ds_read_b64_tr_b16 v[178:179], v26 offset:7168
    s_waitcnt lgkmcnt(2)
    v_mfma_f32_32x32x16_bf16 v[80:95], v[188:191], v[212:215], v[80:95]
    ds_read_b64_tr_b16 v[180:181], v27 offset:6144
    ds_read_b64_tr_b16 v[182:183], v27 offset:7168
    s_waitcnt lgkmcnt(2)
    v_mfma_f32_32x32x16_bf16 v[64:79], v[176:179], v[216:219], v[64:79]
    ds_read_b64_tr_b16 v[184:185], v26 offset:8192
    ds_read_b64_tr_b16 v[186:187], v26 offset:9216
    s_waitcnt lgkmcnt(2)
    v_mfma_f32_32x32x16_bf16 v[80:95], v[180:183], v[216:219], v[80:95]
    ds_read_b64_tr_b16 v[188:189], v27 offset:8192
    ds_read_b64_tr_b16 v[190:191], v27 offset:9216
    s_waitcnt lgkmcnt(2)
    v_mfma_f32_32x32x16_bf16 v[64:79], v[184:187], v[220:223], v[64:79]
    ds_read_b64_tr_b16 v[176:177], v24 offset:6144
    ds_read_b64_tr_b16 v[178:179], v24 offset:7168
    s_waitcnt lgkmcnt(2)
    v_mfma_f32_32x32x16_bf16 v[80:95], v[188:191], v[220:223], v[80:95]
    ds_read_b64_tr_b16 v[180:181], v25 offset:6144
    ds_read_b64_tr_b16 v[182:183], v25 offset:7168
    s_waitcnt lgkmcnt(2)
    v_mfma_f32_32x32x16_bf16 v[64:79], v[176:179], v[224:227], v[64:79]
    ds_read_b64_tr_b16 v[184:185], v24 offset:8192
    ds_read_b64_tr_b16 v[186:187], v24 offset:9216
    s_waitcnt lgkmcnt(2)
    v_mfma_f32_32x32x16_bf16 v[80:95], v[180:183], v[224:227], v[80:95]
    ds_read_b64_tr_b16 v[188:189], v25 offset:8192
    ds_read_b64_tr_b16 v[190:191], v25 offset:9216
    s_waitcnt lgkmcnt(2)
    v_mfma_f32_32x32x16_bf16 v[64:79], v[184:187], v[228:231], v[64:79]
    ds_read_b64_tr_b16 v[176:177], v24 offset:10240
    ds_read_b64_tr_b16 v[178:179], v24 offset:11264
    s_waitcnt lgkmcnt(2)
    v_mfma_f32_32x32x16_bf16 v[80:95], v[188:191], v[228:231], v[80:95]
    ds_read_b64_tr_b16 v[180:181], v25 offset:10240
    ds_read_b64_tr_b16 v[182:183], v25 offset:11264
    s_waitcnt lgkmcnt(2)
    v_mfma_f32_32x32x16_bf16 v[64:79], v[176:179], v[232:235], v[64:79]
    ds_read_b64_tr_b16 v[184:185], v26 offset:10240
    ds_read_b64_tr_b16 v[186:187], v26 offset:11264
    s_waitcnt lgkmcnt(2)
    v_mfma_f32_32x32x16_bf16 v[80:95], v[180:183], v[232:235], v[80:95]
    ds_read_b64_tr_b16 v[188:189], v27 offset:10240
    ds_read_b64_tr_b16 v[190:191], v27 offset:11264
    s_waitcnt lgkmcnt(2)
    v_mfma_f32_32x32x16_bf16 v[64:79], v[184:187], v[236:239], v[64:79]
    ds_read_b64_tr_b16 v[176:177], v26 offset:12288
    ds_read_b64_tr_b16 v[178:179], v26 offset:13312
    s_waitcnt lgkmcnt(2)
    v_mfma_f32_32x32x16_bf16 v[80:95], v[188:191], v[236:239], v[80:95]
    ds_read_b64_tr_b16 v[180:181], v27 offset:12288
    ds_read_b64_tr_b16 v[182:183], v27 offset:13312
    s_waitcnt lgkmcnt(2)
    v_mfma_f32_32x32x16_bf16 v[64:79], v[176:179], v[240:243], v[64:79]
    ds_read_b64_tr_b16 v[184:185], v26 offset:14336
    ds_read_b64_tr_b16 v[186:187], v26 offset:15360
    s_waitcnt lgkmcnt(2)
    v_mfma_f32_32x32x16_bf16 v[80:95], v[180:183], v[240:243], v[80:95]
    ds_read_b64_tr_b16 v[188:189], v27 offset:14336
    ds_read_b64_tr_b16 v[190:191], v27 offset:15360
    s_waitcnt lgkmcnt(2)
    v_mfma_f32_32x32x16_bf16 v[64:79], v[184:187], v[244:247], v[64:79]
    ds_read_b64_tr_b16 v[176:177], v26 offset:16384
    ds_read_b64_tr_b16 v[178:179], v26 offset:17408
    s_waitcnt lgkmcnt(2)
    v_mfma_f32_32x32x16_bf16 v[80:95], v[188:191], v[244:247], v[80:95]
    ds_read_b64_tr_b16 v[180:181], v27 offset:16384
    ds_read_b64_tr_b16 v[182:183], v27 offset:17408
    s_waitcnt lgkmcnt(2)
    v_mfma_f32_32x32x16_bf16 v[64:79], v[176:179], v[248:251], v[64:79]
    ds_read_b64_tr_b16 v[184:185], v26 offset:18432
    ds_read_b64_tr_b16 v[186:187], v26 offset:19456
    s_waitcnt lgkmcnt(2)
    v_mfma_f32_32x32x16_bf16 v[80:95], v[180:183], v[248:251], v[80:95]
    ds_read_b64_tr_b16 v[188:189], v27 offset:18432
    ds_read_b64_tr_b16 v[190:191], v27 offset:19456
    s_waitcnt lgkmcnt(0)
    v_mfma_f32_32x32x16_bf16 v[80:95], v[188:191], v[252:255], v[80:95]
    v_mfma_f32_32x32x16_bf16 v[64:79], v[184:187], v[252:255], v[64:79]
    s_nop 15
    s_branch L_ok
L_gspecial0:
    s_lshl_b32 s59, s56, 17
    s_lshl_b32 s63, s54, 12
    s_add_u32 s96, s59, s63
    s_sub_u32 s96, s96, 16384
    s_add_u32 s60, s96, 0
    s_add_u32 m0, s61, 0
    s_cmp_ge_u32 s54, 4
    s_cbranch_scc1 L_gk0
    buffer_load_dwordx4 v161, s[32:35], s59 offen sc1 lds
    s_mov_b32 s60, 16777216
    s_branch L_gk0e
L_gk0:
    buffer_load_dwordx4 v2, s[32:35], s60 offen sc1 lds
L_gk0e:
    buffer_load_dwordx4 v2, s[32:35], s60 offen offset:1024 sc1 lds
    s_add_u32 s60, s96, 2048
    s_add_u32 m0, s61, 8320
    s_cmp_ge_u32 s54, 4
    s_cbranch_scc1 L_gk1
    buffer_load_dwordx4 v161, s[32:35], s59 offen sc1 lds
    s_mov_b32 s60, 16777216
    s_branch L_gk1e
L_gk1:
    buffer_load_dwordx4 v2, s[32:35], s60 offen sc1 lds
L_gk1e:
    buffer_load_dwordx4 v2, s[32:35], s60 offen offset:1024 sc1 lds
    s_branch L_gdone0
L_gspecial1:
    s_add_u32 s60, s96, 4096
    s_add_u32 m0, s61, 16640
    s_cmp_ge_u32 s54, 3
    s_cbranch_scc1 L_gk2
    buffer_load_dwordx4 v161, s[32:35], s59 offen sc1 lds
    s_mov_b32 s60, 16777216
    s_branch L_gk2e
L_gk2:
    buffer_load_dwordx4 v2, s[32:35], s60 offen sc1 lds
L_gk2e:
    buffer_load_dwordx4 v2, s[32:35], s60 offen offset:1024 sc1 lds
    s_add_u32 s60, s96, 6144
    s_add_u32 m0, s61, 24960
    s_cmp_ge_u32 s54, 3
    s_cbranch_scc1 L_gk3
    buffer_load_dwordx4 v161, s[32:35], s59 offen sc1 lds
    s_mov_b32 s60, 16777216
    s_branch L_gk3e
L_gk3:
    buffer_load_dwordx4 v2, s[32:35], s60 offen sc1 lds
L_gk3e:
    buffer_load_dwordx4 v2, s[32:35], s60 offen offset:1024 sc1 lds
    s_add_u32 s60, s96, 8192
    s_add_u32 m0, s61, 33280
    s_cmp_ge_u32 s54, 2
    s_cbranch_scc1 L_gk4
    buffer_load_dwordx4 v161, s[32:35], s59 offen sc1 lds
    s_mov_b32 s60, 16777216
    s_branch L_gk4e
L_gk4:
    buffer_load_dwordx4 v2, s[32:35], s60 offen sc1 lds
L_gk4e:
    buffer_load_dwordx4 v2, s[32:35], s60 offen offset:1024 sc1 lds
    s_add_u32 s60, s96, 10240
    s_add_u32 m0, s61, 41600
    s_cmp_ge_u32 s54, 2
    s_cbranch_scc1 L_gk5
    buffer_load_dwordx4 v161, s[32:35], s59 offen sc1 lds
    s_mov_b32 s60, 16777216
    s_branch L_gk5e
L_gk5:
    buffer_load_dwordx4 v2, s[32:35], s60 offen sc1 lds
L_gk5e:
    buffer_load_dwordx4 v2, s[32:35], s60 offen offset:1024 sc1 lds
    s_add_u32 s60, s96, 12288
    s_add_u32 m0, s61, 49920
    s_cmp_ge_u32 s54, 1
    s_cbranch_scc1 L_gk6
    buffer_load_dwordx4 v161, s[32:35], s59 offen sc1 lds
    s_mov_b32 s60, 16777216
    s_branch L_gk6e
L_gk6:
    buffer_load_dwordx4 v2, s[32:35], s60 offen sc1 lds
L_gk6e:
    buffer_load_dwordx4 v2, s[32:35], s60 offen offset:1024 sc1 lds
    s_add_u32 s60, s96, 14336
    s_add_u32 m0, s61, 58240
    s_cmp_ge_u32 s54, 1
    s_cbranch_scc1 L_gk7
    buffer_load_dwordx4 v161, s[32:35], s59 offen sc1 lds
    s_mov_b32 s60, 16777216
    s_branch L_gk7e
L_gk7:
    buffer_load_dwordx4 v2, s[32:35], s60 offen sc1 lds
L_gk7e:
    buffer_load_dwordx4 v2, s[32:35], s60 offen offset:1024 sc1 lds
    s_branch L_gdone1
L_exact0:
    s_waitcnt vmcnt(0) lgkmcnt(0)
    s_nop 15
    s_lshl_b32 s60, s54, 1
    s_sub_u32 s60, s60, 8
    v_lshrrev_b32 v31, 1, v2
    v_and_b32 v31, 0x100, v31
    v_and_b32 v30, 0xf0, v2
    v_or_b32 v31, v31, v30
    s_add_i32 s59, s60, 8
    s_cmp_ge_i32 s59, 0
    s_cselect_b64 vcc, -1, 0
    s_cselect_b32 s100, 0x3f803f80, 0
    s_max_i32 s59, s59, 0
    s_lshl_b32 s59, s59, 11
    s_lshl_b32 s63, s56, 17
    s_add_u32 s59, s59, s63
    v_and_b32 v30, 0x200, v2
    v_cndmask_b32 v30, v30, v2, vcc
    buffer_load_dwordx4 v[152:155], v30, s[32:35], s59 offen sc1
    v_mov_b32 v192, s100
    v_mov_b32 v193, s100
    v_mov_b32 v194, s100
    v_mov_b32 v195, s100
    v_mov_b32 v196, s100
    v_mov_b32 v197, s100
    v_mov_b32 v198, s100
    v_mov_b32 v199, s100
    s_cmp_lg_u32 s100, 0
    s_cselect_b32 s59, s59, 16777216
    s_mov_b64 exec, s[98:99]
    buffer_load_dwordx4 v[192:195], v31, s[32:35], s59 offen offset:1024 sc1
    buffer_load_dwordx4 v[196:199], v31, s[32:35], s59 offen offset:1536 sc1
    s_mov_b64 exec, -1
    s_add_i32 s59, s60, 0
    s_cmp_ge_i32 s59, 0
    s_cselect_b64 vcc, -1, 0
    s_cselect_b32 s100, 0x3f803f80, 0
    s_max_i32 s59, s59, 0
    s_lshl_b32 s59, s59, 11
    s_lshl_b32 s63, s56, 17
    s_add_u32 s59, s59, s63
    v_and_b32 v30, 0x200, v2
    v_cndmask_b32 v30, v30, v2, vcc
    buffer_load_dwordx4 v[156:159], v30, s[32:35], s59 offen sc1
    v_mov_b32 v200, s100
    v_mov_b32 v201, s100
    v_mov_b32 v202, s100
    v_mov_b32 v203, s100
    v_mov_b32 v204, s100
    v_mov_b32 v205, s100
    v_mov_b32 v206, s100
    v_mov_b32 v207, s100
    s_cmp_lg_u32 s100, 0
    s_cselect_b32 s59, s59, 16777216
    s_mov_b64 exec, s[98:99]
    buffer_load_dwordx4 v[200:203], v31, s[32:35], s59 offen offset:1024 sc1
    buffer_load_dwordx4 v[204:207], v31, s[32:35], s59 offen offset:1536 sc1
    s_mov_b64 exec, -1
    s_waitcnt vmcnt(5)
    v_mfma_f32_32x32x16_bf16 v[96:111], v[152:155], v[24:27], 0
    s_waitcnt vmcnt(2)
    v_mfma_f32_32x32x16_bf16 v[32:47], v[156:159], v[24:27], 0
    s_nop 11
    v_cndmask_b32 v96, v32, v96, s[64:65]
    v_cndmask_b32 v97, v33, v97, s[66:67]
    v_cndmask_b32 v98, v34, v98, s[68:69]
    v_cndmask_b32 v99, v35, v99, s[70:71]
    v_cndmask_b32 v100, v36, v100, s[72:73]
    v_cndmask_b32 v101, v37, v101, s[74:75]
    v_cndmask_b32 v102, v38, v102, s[76:77]
    v_cndmask_b32 v103, v39, v103, s[78:79]
    v_cndmask_b32 v104, v40, v104, s[80:81]
    v_cndmask_b32 v105, v41, v105, s[82:83]
    v_cndmask_b32 v106, v42, v106, s[84:85]
    v_cndmask_b32 v107, v43, v107, s[86:87]
    v_cndmask_b32 v108, v44, v108, s[88:89]
    v_cndmask_b32 v109, v45, v109, s[90:91]
    v_cndmask_b32 v110, v46, v110, s[92:93]
    v_cndmask_b32 v111, v47, v111, s[94:95]
    v_max3_f32 v28, v96, v97, v98
    v_max3_f32 v28, v28, v99, v100
    v_max3_f32 v28, v28, v101, v102
    v_max3_f32 v28, v28, v103, v104
    v_max3_f32 v28, v28, v105, v106
    v_max3_f32 v28, v28, v107, v108
    v_max3_f32 v28, v28, v109, v110
    v_max_f32 v28, v28, v111
    s_mov_b32 s101, 7
L_exact_m0:
    s_add_u32 s60, s60, 1
    s_add_i32 s59, s60, 0
    s_cmp_ge_i32 s59, 0
    s_cselect_b64 vcc, -1, 0
    s_cselect_b32 s100, 0x3f803f80, 0
    s_max_i32 s59, s59, 0
    s_lshl_b32 s59, s59, 11
    s_lshl_b32 s63, s56, 17
    s_add_u32 s59, s59, s63
    v_and_b32 v30, 0x200, v2
    v_cndmask_b32 v30, v30, v2, vcc
    buffer_load_dwordx4 v[152:155], v30, s[32:35], s59 offen sc1
    s_waitcnt vmcnt(0)
    v_mfma_f32_32x32x16_bf16 v[32:47], v[152:155], v[24:27], 0
    s_nop 11
    v_max3_f32 v28, v28, v32, v33
    v_max3_f32 v28, v28, v34, v35
    v_max3_f32 v28, v28, v36, v37
    v_max3_f32 v28, v28, v38, v39
    v_max3_f32 v28, v28, v40, v41
    v_max3_f32 v28, v28, v42, v43
    v_max3_f32 v28, v28, v44, v45
    v_max3_f32 v28, v28, v46, v47
    s_sub_u32 s101, s101, 1
    s_cmp_lg_u32 s101, 0
    s_cbranch_scc1 L_exact_m0
    v_mov_b32 v29, v28
    s_nop 1
    v_permlane32_swap_b32 v28, v29
    v_max_f32 v28, v28, v29
    v_sub_f32 v96, v96, v28
    v_sub_f32 v97, v97, v28
    v_sub_f32 v98, v98, v28
    v_sub_f32 v99, v99, v28
    v_sub_f32 v100, v100, v28
    v_sub_f32 v101, v101, v28
    v_sub_f32 v102, v102, v28
    v_sub_f32 v103, v103, v28
    v_sub_f32 v104, v104, v28
    v_sub_f32 v105, v105, v28
    v_sub_f32 v106, v106, v28
    v_sub_f32 v107, v107, v28
    v_sub_f32 v108, v108, v28
    v_sub_f32 v109, v109, v28
    v_sub_f32 v110, v110, v28
    v_sub_f32 v111, v111, v28
    v_exp_f32 v96, v96
    v_exp_f32 v97, v97
    v_exp_f32 v98, v98
    v_exp_f32 v99, v99
    v_exp_f32 v100, v100
    v_exp_f32 v101, v101
    v_exp_f32 v102, v102
    v_exp_f32 v103, v103
    v_exp_f32 v104, v104
    v_exp_f32 v105, v105
    v_exp_f32 v106, v106
    v_exp_f32 v107, v107
    v_exp_f32 v108, v108
    v_exp_f32 v109, v109
    v_exp_f32 v110, v110
    v_exp_f32 v111, v111
    v_cvt_pk_bf16_f32 v144, v96, v97
    v_cvt_pk_bf16_f32 v145, v98, v99
    v_cvt_pk_bf16_f32 v146, v100, v101
    v_cvt_pk_bf16_f32 v147, v102, v103
    v_cvt_pk_bf16_f32 v148, v104, v105
    v_cvt_pk_bf16_f32 v149, v106, v107
    v_cvt_pk_bf16_f32 v150, v108, v109
    v_cvt_pk_bf16_f32 v151, v110, v111
    v_and_b32 v128, v16, v144
    v_and_b32 v129, v17, v145
    v_and_b32 v130, v18, v146
    v_and_b32 v131, v19, v147
    v_and_b32 v132, v20, v148
    v_and_b32 v133, v21, v149
    v_and_b32 v134, v22, v150
    v_and_b32 v135, v23, v151
    v_xor_b32 v144, v144, v128
    v_xor_b32 v145, v145, v129
    v_xor_b32 v146, v146, v130
    v_xor_b32 v147, v147, v131
    v_xor_b32 v148, v148, v132
    v_xor_b32 v149, v149, v133
    v_xor_b32 v150, v150, v134
    v_xor_b32 v151, v151, v135
    v_mfma_f32_32x32x16_bf16 v[160:175], v[192:195], v[128:131], 0
    v_mfma_f32_32x32x16_bf16 v[160:175], v[196:199], v[132:135], v[160:175]
    v_mfma_f32_32x32x16_bf16 v[160:175], v[200:203], v[144:147], v[160:175]
    v_mfma_f32_32x32x16_bf16 v[160:175], v[204:207], v[148:151], v[160:175]
    s_sub_u32 s60, s60, 7
    s_mov_b32 s101, 7
    s_nop 15
L_exact_e0:
    s_add_u32 s60, s60, 1
    s_add_i32 s59, s60, 0
    s_cmp_ge_i32 s59, 0
    s_cselect_b64 vcc, -1, 0
    s_cselect_b32 s100, 0x3f803f80, 0
    s_max_i32 s59, s59, 0
    s_lshl_b32 s59, s59, 11
    s_lshl_b32 s63, s56, 17
    s_add_u32 s59, s59, s63
    v_and_b32 v30, 0x200, v2
    v_cndmask_b32 v30, v30, v2, vcc
    buffer_load_dwordx4 v[152:155], v30, s[32:35], s59 offen sc1
    v_mov_b32 v192, s100
    v_mov_b32 v193, s100
    v_mov_b32 v194, s100
    v_mov_b32 v195, s100
    v_mov_b32 v196, s100
    v_mov_b32 v197, s100
    v_mov_b32 v198, s100
    v_mov_b32 v199, s100
    s_cmp_lg_u32 s100, 0
    s_cselect_b32 s59, s59, 16777216
    s_mov_b64 exec, s[98:99]
    buffer_load_dwordx4 v[192:195], v31, s[32:35], s59 offen offset:1024 sc1
    buffer_load_dwordx4 v[196:199], v31, s[32:35], s59 offen offset:1536 sc1
    s_mov_b64 exec, -1
    s_waitcnt vmcnt(2)
    v_mfma_f32_32x32x16_bf16 v[32:47], v[152:155], v[24:27], 0
    s_nop 11
    v_sub_f32 v32, v32, v28
    v_sub_f32 v33, v33, v28
    v_sub_f32 v34, v34, v28
    v_sub_f32 v35, v35, v28
    v_sub_f32 v36, v36, v28
    v_sub_f32 v37, v37, v28
    v_sub_f32 v38, v38, v28
    v_sub_f32 v39, v39, v28
    v_sub_f32 v40, v40, v28
    v_sub_f32 v41, v41, v28
    v_sub_f32 v42, v42, v28
    v_sub_f32 v43, v43, v28
    v_sub_f32 v44, v44, v28
    v_sub_f32 v45, v45, v28
    v_sub_f32 v46, v46, v28
    v_sub_f32 v47, v47, v28
    v_exp_f32 v32, v32
    v_exp_f32 v33, v33
    v_exp_f32 v34, v34
    v_exp_f32 v35, v35
    v_exp_f32 v36, v36
    v_exp_f32 v37, v37
    v_exp_f32 v38, v38
    v_exp_f32 v39, v39
    v_exp_f32 v40, v40
    v_exp_f32 v41, v41
    v_exp_f32 v42, v42
    v_exp_f32 v43, v43
    v_exp_f32 v44, v44
    v_exp_f32 v45, v45
    v_exp_f32 v46, v46
    v_exp_f32 v47, v47
    v_cvt_pk_bf16_f32 v128, v32, v33
    v_cvt_pk_bf16_f32 v129, v34, v35
    v_cvt_pk_bf16_f32 v130, v36, v37
    v_cvt_pk_bf16_f32 v131, v38, v39
    v_cvt_pk_bf16_f32 v132, v40, v41
    v_cvt_pk_bf16_f32 v133, v42, v43
    v_cvt_pk_bf16_f32 v134, v44, v45
    v_cvt_pk_bf16_f32 v135, v46, v47
    s_waitcnt vmcnt(1)
    v_mfma_f32_32x32x16_bf16 v[160:175], v[192:195], v[128:131], v[160:175]
    s_waitcnt vmcnt(0)
    v_mfma_f32_32x32x16_bf16 v[160:175], v[196:199], v[132:135], v[160:175]
    s_nop 15
    s_sub_u32 s101, s101, 1
    s_cmp_lg_u32 s101, 0
    s_cbranch_scc1 L_exact_e0
L_exact1:
    s_waitcnt vmcnt(0) lgkmcnt(0)
    s_nop 15
    s_lshl_b32 s60, s54, 1
    s_sub_u32 s60, s60, 7
    v_lshrrev_b32 v31, 1, v2
    v_and_b32 v31, 0x100, v31
    v_and_b32 v30, 0xf0, v2
    v_or_b32 v31, v31, v30
    s_add_i32 s59, s60, 8
    s_cmp_ge_i32 s59, 0
    s_cselect_b64 vcc, -1, 0
    s_cselect_b32 s100, 0x3f803f80, 0
    s_max_i32 s59, s59, 0
    s_lshl_b32 s59, s59, 11
    s_lshl_b32 s63, s56, 17
    s_add_u32 s59, s59, s63
    v_and_b32 v30, 0x200, v2
    v_cndmask_b32 v30, v30, v2, vcc
    buffer_load_dwordx4 v[152:155], v30, s[32:35], s59 offen sc1
    v_mov_b32 v192, s100
    v_mov_b32 v193, s100
    v_mov_b32 v194, s100
    v_mov_b32 v195, s100
    v_mov_b32 v196, s100
    v_mov_b32 v197, s100
    v_mov_b32 v198, s100
    v_mov_b32 v199, s100
    s_cmp_lg_u32 s100, 0
    s_cselect_b32 s59, s59, 16777216
    s_mov_b64 exec, s[98:99]
    buffer_load_dwordx4 v[192:195], v31, s[32:35], s59 offen offset:1024 sc1
    buffer_load_dwordx4 v[196:199], v31, s[32:35], s59 offen offset:1536 sc1
    s_mov_b64 exec, -1
    s_add_i32 s59, s60, 0
    s_cmp_ge_i32 s59, 0
    s_cselect_b64 vcc, -1, 0
    s_cselect_b32 s100, 0x3f803f80, 0
    s_max_i32 s59, s59, 0
    s_lshl_b32 s59, s59, 11
    s_lshl_b32 s63, s56, 17
    s_add_u32 s59, s59, s63
    v_and_b32 v30, 0x200, v2
    v_cndmask_b32 v30, v30, v2, vcc
    buffer_load_dwordx4 v[156:159], v30, s[32:35], s59 offen sc1
    v_mov_b32 v200, s100
    v_mov_b32 v201, s100
    v_mov_b32 v202, s100
    v_mov_b32 v203, s100
    v_mov_b32 v204, s100
    v_mov_b32 v205, s100
    v_mov_b32 v206, s100
    v_mov_b32 v207, s100
    s_cmp_lg_u32 s100, 0
    s_cselect_b32 s59, s59, 16777216
    s_mov_b64 exec, s[98:99]
    buffer_load_dwordx4 v[200:203], v31, s[32:35], s59 offen offset:1024 sc1
    buffer_load_dwordx4 v[204:207], v31, s[32:35], s59 offen offset:1536 sc1
    s_mov_b64 exec, -1
    s_waitcnt vmcnt(5)
    v_mfma_f32_32x32x16_bf16 v[96:111], v[152:155], v[216:219], 0
    s_waitcnt vmcnt(2)
    v_mfma_f32_32x32x16_bf16 v[32:47], v[156:159], v[216:219], 0
    s_nop 11
    v_cndmask_b32 v96, v32, v96, s[64:65]
    v_cndmask_b32 v97, v33, v97, s[66:67]
    v_cndmask_b32 v98, v34, v98, s[68:69]
    v_cndmask_b32 v99, v35, v99, s[70:71]
    v_cndmask_b32 v100, v36, v100, s[72:73]
    v_cndmask_b32 v101, v37, v101, s[74:75]
    v_cndmask_b32 v102, v38, v102, s[76:77]
    v_cndmask_b32 v103, v39, v103, s[78:79]
    v_cndmask_b32 v104, v40, v104, s[80:81]
    v_cndmask_b32 v105, v41, v105, s[82:83]
    v_cndmask_b32 v106, v42, v106, s[84:85]
    v_cndmask_b32 v107, v43, v107, s[86:87]
    v_cndmask_b32 v108, v44, v108, s[88:89]
    v_cndmask_b32 v109, v45, v109, s[90:91]
    v_cndmask_b32 v110, v46, v110, s[92:93]
    v_cndmask_b32 v111, v47, v111, s[94:95]
    v_max3_f32 v28, v96, v97, v98
    v_max3_f32 v28, v28, v99, v100
    v_max3_f32 v28, v28, v101, v102
    v_max3_f32 v28, v28, v103, v104
    v_max3_f32 v28, v28, v105, v106
    v_max3_f32 v28, v28, v107, v108
    v_max3_f32 v28, v28, v109, v110
    v_max_f32 v28, v28, v111
    s_mov_b32 s101, 7
L_exact_m1:
    s_add_u32 s60, s60, 1
    s_add_i32 s59, s60, 0
    s_cmp_ge_i32 s59, 0
    s_cselect_b64 vcc, -1, 0
    s_cselect_b32 s100, 0x3f803f80, 0
    s_max_i32 s59, s59, 0
    s_lshl_b32 s59, s59, 11
    s_lshl_b32 s63, s56, 17
    s_add_u32 s59, s59, s63
    v_and_b32 v30, 0x200, v2
    v_cndmask_b32 v30, v30, v2, vcc
    buffer_load_dwordx4 v[152:155], v30, s[32:35], s59 offen sc1
    s_waitcnt vmcnt(0)
    v_mfma_f32_32x32x16_bf16 v[32:47], v[152:155], v[216:219], 0
    s_nop 11
    v_max3_f32 v28, v28, v32, v33
    v_max3_f32 v28, v28, v34, v35
    v_max3_f32 v28, v28, v36, v37
    v_max3_f32 v28, v28, v38, v39
    v_max3_f32 v28, v28, v40, v41
    v_max3_f32 v28, v28, v42, v43
    v_max3_f32 v28, v28, v44, v45
    v_max3_f32 v28, v28, v46, v47
    s_sub_u32 s101, s101, 1
    s_cmp_lg_u32 s101, 0
    s_cbranch_scc1 L_exact_m1
    v_mov_b32 v29, v28
    s_nop 1
    v_permlane32_swap_b32 v28, v29
    v_max_f32 v28, v28, v29
    v_sub_f32 v96, v96, v28
    v_sub_f32 v97, v97, v28
    v_sub_f32 v98, v98, v28
    v_sub_f32 v99, v99, v28
    v_sub_f32 v100, v100, v28
    v_sub_f32 v101, v101, v28
    v_sub_f32 v102, v102, v28
    v_sub_f32 v103, v103, v28
    v_sub_f32 v104, v104, v28
    v_sub_f32 v105, v105, v28
    v_sub_f32 v106, v106, v28
    v_sub_f32 v107, v107, v28
    v_sub_f32 v108, v108, v28
    v_sub_f32 v109, v109, v28
    v_sub_f32 v110, v110, v28
    v_sub_f32 v111, v111, v28
    v_exp_f32 v96, v96
    v_exp_f32 v97, v97
    v_exp_f32 v98, v98
    v_exp_f32 v99, v99
    v_exp_f32 v100, v100
    v_exp_f32 v101, v101
    v_exp_f32 v102, v102
    v_exp_f32 v103, v103
    v_exp_f32 v104, v104
    v_exp_f32 v105, v105
    v_exp_f32 v106, v106
    v_exp_f32 v107, v107
    v_exp_f32 v108, v108
    v_exp_f32 v109, v109
    v_exp_f32 v110, v110
    v_exp_f32 v111, v111
    v_cvt_pk_bf16_f32 v144, v96, v97
    v_cvt_pk_bf16_f32 v145, v98, v99
    v_cvt_pk_bf16_f32 v146, v100, v101
    v_cvt_pk_bf16_f32 v147, v102, v103
    v_cvt_pk_bf16_f32 v148, v104, v105
    v_cvt_pk_bf16_f32 v149, v106, v107
    v_cvt_pk_bf16_f32 v150, v108, v109
    v_cvt_pk_bf16_f32 v151, v110, v111
    v_and_b32 v128, v16, v144
    v_and_b32 v129, v17, v145
    v_and_b32 v130, v18, v146
    v_and_b32 v131, v19, v147
    v_and_b32 v132, v20, v148
    v_and_b32 v133, v21, v149
    v_and_b32 v134, v22, v150
    v_and_b32 v135, v23, v151
    v_xor_b32 v144, v144, v128
    v_xor_b32 v145, v145, v129
    v_xor_b32 v146, v146, v130
    v_xor_b32 v147, v147, v131
    v_xor_b32 v148, v148, v132
    v_xor_b32 v149, v149, v133
    v_xor_b32 v150, v150, v134
    v_xor_b32 v151, v151, v135
    v_mfma_f32_32x32x16_bf16 v[176:191], v[192:195], v[128:131], 0
    v_mfma_f32_32x32x16_bf16 v[176:191], v[196:199], v[132:135], v[176:191]
    v_mfma_f32_32x32x16_bf16 v[176:191], v[200:203], v[144:147], v[176:191]
    v_mfma_f32_32x32x16_bf16 v[176:191], v[204:207], v[148:151], v[176:191]
    s_sub_u32 s60, s60, 7
    s_mov_b32 s101, 7
    s_nop 15
L_exact_e1:
    s_add_u32 s60, s60, 1
    s_add_i32 s59, s60, 0
    s_cmp_ge_i32 s59, 0
    s_cselect_b64 vcc, -1, 0
    s_cselect_b32 s100, 0x3f803f80, 0
    s_max_i32 s59, s59, 0
    s_lshl_b32 s59, s59, 11
    s_lshl_b32 s63, s56, 17
    s_add_u32 s59, s59, s63
    v_and_b32 v30, 0x200, v2
    v_cndmask_b32 v30, v30, v2, vcc
    buffer_load_dwordx4 v[152:155], v30, s[32:35], s59 offen sc1
    v_mov_b32 v192, s100
    v_mov_b32 v193, s100
    v_mov_b32 v194, s100
    v_mov_b32 v195, s100
    v_mov_b32 v196, s100
    v_mov_b32 v197, s100
    v_mov_b32 v198, s100
    v_mov_b32 v199, s100
    s_cmp_lg_u32 s100, 0
    s_cselect_b32 s59, s59, 16777216
    s_mov_b64 exec, s[98:99]
    buffer_load_dwordx4 v[192:195], v31, s[32:35], s59 offen offset:1024 sc1
    buffer_load_dwordx4 v[196:199], v31, s[32:35], s59 offen offset:1536 sc1
    s_mov_b64 exec, -1
    s_waitcnt vmcnt(2)
    v_mfma_f32_32x32x16_bf16 v[32:47], v[152:155], v[216:219], 0
    s_nop 11
    v_sub_f32 v32, v32, v28
    v_sub_f32 v33, v33, v28
    v_sub_f32 v34, v34, v28
    v_sub_f32 v35, v35, v28
    v_sub_f32 v36, v36, v28
    v_sub_f32 v37, v37, v28
    v_sub_f32 v38, v38, v28
    v_sub_f32 v39, v39, v28
    v_sub_f32 v40, v40, v28
    v_sub_f32 v41, v41, v28
    v_sub_f32 v42, v42, v28
    v_sub_f32 v43, v43, v28
    v_sub_f32 v44, v44, v28
    v_sub_f32 v45, v45, v28
    v_sub_f32 v46, v46, v28
    v_sub_f32 v47, v47, v28
    v_exp_f32 v32, v32
    v_exp_f32 v33, v33
    v_exp_f32 v34, v34
    v_exp_f32 v35, v35
    v_exp_f32 v36, v36
    v_exp_f32 v37, v37
    v_exp_f32 v38, v38
    v_exp_f32 v39, v39
    v_exp_f32 v40, v40
    v_exp_f32 v41, v41
    v_exp_f32 v42, v42
    v_exp_f32 v43, v43
    v_exp_f32 v44, v44
    v_exp_f32 v45, v45
    v_exp_f32 v46, v46
    v_exp_f32 v47, v47
    v_cvt_pk_bf16_f32 v128, v32, v33
    v_cvt_pk_bf16_f32 v129, v34, v35
    v_cvt_pk_bf16_f32 v130, v36, v37
    v_cvt_pk_bf16_f32 v131, v38, v39
    v_cvt_pk_bf16_f32 v132, v40, v41
    v_cvt_pk_bf16_f32 v133, v42, v43
    v_cvt_pk_bf16_f32 v134, v44, v45
    v_cvt_pk_bf16_f32 v135, v46, v47
    s_waitcnt vmcnt(1)
    v_mfma_f32_32x32x16_bf16 v[176:191], v[192:195], v[128:131], v[176:191]
    s_waitcnt vmcnt(0)
    v_mfma_f32_32x32x16_bf16 v[176:191], v[196:199], v[132:135], v[176:191]
    s_nop 15
    s_sub_u32 s101, s101, 1
    s_cmp_lg_u32 s101, 0
    s_cbranch_scc1 L_exact_e1
    s_branch L_back
    .fill 3072, 4, 0xbf800000
.section .rodata,"a"
.p2align 6
.amdhsa_kernel gated_mix__sliding_block__sliding_local_dilated__prompt_kernel
  .amdhsa_next_free_vgpr 256
  .amdhsa_next_free_sgpr 102
  .amdhsa_accum_offset 256
  .amdhsa_group_segment_fixed_size 0
  .amdhsa_kernarg_size 80
  .amdhsa_user_sgpr_count 2
  .amdhsa_user_sgpr_kernarg_segment_ptr 1
  .amdhsa_system_sgpr_workgroup_id_x 1
.end_amdhsa_kernel
```
